```python
import torch

def _softmax(x, axis=-1):
    return torch.softmax(x, dim=axis)
def _gelu(x):
    return torch.nn.functional.gelu(x, approximate="tanh")
def _silu(x):
    return torch.nn.functional.silu(x)
def _sigmoid(x):
    return torch.sigmoid(x)
def _layernorm(x, axis=-1, eps=1e-5):
    m = x.mean(dim=axis, keepdim=True)
    v = x.var(dim=axis, keepdim=True, unbiased=False)
    return (x - m) / torch.sqrt(v + eps)
def _scatter_add(tgt, idx, src, axis=0):
    return tgt.clone().index_add_(axis, idx, src)
def _segment_sum(src, seg, n):
    out = torch.zeros((n,) + src.shape[1:], dtype=src.dtype)
    return out.index_add_(0, seg, src)
def _pad(x, pw):
    flat = tuple(v for pair in reversed(pw) for v in pair)
    return torch.nn.functional.pad(x, flat)

kernel_name = 'standalone__gqa_softmax__near_ridge'

def setup_inputs():

    _w = (lambda a: (lambda t: t.to(torch.bfloat16) if t.is_floating_point() else t)(torch.as_tensor(a)))
    B, Hq, Hkv, Sq, Sk, D = 16, 32, 4, 48, 1024, 128
    return {
        "q": _w((lambda *s: torch.randn(*s, dtype=torch.bfloat16) * 0.8)(B, Hq, Sq, D)),
        "k": _w((lambda *s: torch.randn(*s, dtype=torch.bfloat16) * 0.8)(B, Hkv, Sk, D)),
        "v": _w((lambda *s: torch.randn(*s, dtype=torch.bfloat16) * 0.05)(B, Hkv, Sk, D)),
    }

def reference(q, k, v):
    B, Hq, Sq, D = q.shape
    Hkv = k.shape[1]
    rep = Hq // Hkv
    k = (lambda x, n, axis: torch.repeat_interleave(x, n, dim=axis))(k, rep, axis=1)
    v = (lambda x, n, axis: torch.repeat_interleave(x, n, dim=axis))(v, rep, axis=1)
    scale = D ** -0.5
    scores = torch.einsum("bhqd,bhkd->bhqk", q, k) * scale
    p = _softmax(scores, axis=-1)
    return torch.einsum("bhqk,bhkd->bhqd", p, v)
```

```asm
; @launch grid=(256,1,1) block=(256,1,1) lds=163840
.amdgcn_target "amdgcn-amd-amdhsa--gfx950"
.text
.globl standalone__gqa_softmax__near_ridge_kernel
.p2align 8
.type standalone__gqa_softmax__near_ridge_kernel,@function
standalone__gqa_softmax__near_ridge_kernel:
  s_load_dwordx8 s[4:11], s[0:1], 0
  s_getpc_b64 s[44:45]
  s_nop 0
L_pc:
  s_lshr_b32 s41, s2, 3
  v_lshrrev_b32 v1, 5, v0
  s_lshl_b32 s33, s41, 10
  s_nop 0
  v_lshl_add_u32 v1, v1, 7, s33
  v_min_u32 v1, (L_codeend-L_pc-4), v1
  global_load_dword v239, v1, s[44:45]
  s_cmp_ge_u32 s2, 256
  s_cbranch_scc1 L_end
  v_lshrrev_b32 v1, 6, v0
  v_and_b32 v2, 63, v0
  v_readfirstlane_b32 s28, v1
  s_and_b32 s40, s2, 7
  s_lshr_b32 s41, s2, 3
  s_lshl_b32 s42, s40, 3
  s_lshr_b32 s43, s41, 2
  s_add_u32 s29, s42, s43
  s_and_b32 s30, s41, 3
  v_lshlrev_b32_e64 v3, 4, v2
  s_mul_i32 s32, s29, 98304
  s_mul_i32 s42, s30, 24576
  s_add_u32 s32, s32, s42
  s_nop 0
  s_mul_i32 s46, s28, 6144
  s_add_u32 s47, s46, s32
  s_nop 0
  s_add_u32 s48, s47, 4096
  v_lshrrev_b32 v237, 4, v2
  v_and_b32 v238, 15, v2
  v_xor_b32 v235, v238, v237
  v_lshlrev_b32 v236, 8, v237
  v_lshl_add_u32 v4, v235, 4, v236
  v_xor_b32_e64 v5, 64, v4
  v_add_u32 v5, 31744, v5
  v_xor_b32 v6, 128, v4
  v_add_u32 v6, 63488, v6
  v_xor_b32 v7, 192, v4
  v_add_u32 v7, 95232, v7
  s_lshl_b32 s54, s29, 18
  s_nop 0
  s_mul_i32 s41, s28, 1024
  s_add_u32 s52, s54, s41
  s_add_u32 s64, s52, 0
  s_add_u32 s72, s64, 131072
  s_lshl_b32 s35, s28, 15
  s_mov_b32 s38, 0
  s_mov_b32 s14, 0x600000
  s_mov_b32 s15, 0x20000
  s_mov_b32 s18, 0x1000000
  s_mov_b32 s19, 0x20000
  s_mov_b32 s22, 0x1000000
  s_mov_b32 s23, 0x20000
  s_mov_b32 s26, 0x600000
  s_mov_b32 s27, 0x20000
  s_waitcnt lgkmcnt(0)
  s_mov_b64 s[12:13], s[4:5]
  s_mov_b64 s[16:17], s[6:7]
  s_mov_b64 s[20:21], s[8:9]
  s_mov_b64 s[24:25], s[10:11]
  s_mov_b64 exec, 1
  buffer_load_dword v239, v3, s[20:23], s64 offen
  s_mov_b64 exec, -1
  s_nop 0
L_restart:
  s_add_u32 m0, s35, 24576
  buffer_load_dwordx4 v[112:115], v3, s[12:15], s47 offen
  buffer_load_dwordx4 v3, s[16:19], s54 offen lds
  buffer_load_dwordx4 v[116:119], v3, s[12:15], s47 offen offset:1024
  buffer_load_dwordx4 v[120:123], v3, s[12:15], s47 offen offset:2048
  buffer_load_dwordx4 v[124:127], v3, s[12:15], s47 offen offset:3072
  buffer_load_dwordx4 v[128:131], v3, s[12:15], s48 offen offset:0
  buffer_load_dwordx4 v[132:135], v3, s[12:15], s48 offen offset:1024
  s_add_u32 m0, s35, 0
  s_nop 0
  buffer_load_dwordx4 v4, s[16:19], s64 offen offset:0 lds
  buffer_load_dwordx4 v5, s[16:19], s64 offen offset:1024 lds
  s_mov_b32 s36, 0x3e0293ee
  s_mov_b32 s37, 0x3e0293ee
  v_xor_b32 v233, v238, v237
  v_lshlrev_b32 v232, 8, v238
  v_lshl_add_u32 v232, v233, 4, v232
  v_add_u32 v10, s35, v232
  s_lshr_b32 s55, s28, 1
  s_mul_i32 s55, s55, 12288
  s_add_u32 s40, s55, 131072
  s_sub_u32 s41, 143360, s55
  v_add_u32 v136, s40, v232
  v_add_u32 v140, s41, v232
  v_xor_b32 v11, 64, v10
  v_xor_b32 v137, 64, v136
  v_xor_b32_e64 v141, 64, v140
  v_xor_b32 v12, 128, v10
  v_xor_b32 v138, 128, v136
  v_xor_b32 v142, 128, v140
  v_xor_b32 v13, 192, v10
  v_xor_b32 v139, 192, v136
  v_xor_b32 v143, 192, v140
  s_and_b32 s43, s28, 1
  s_lshl_b32 s43, s43, 7
  s_add_u32 s41, s46, 131072
  v_xor_b32 v144, s43, v4
  v_add_u32 v144, s41, v144
  v_xor_b32_e64 v145, 64, v144
  v_xor_b32 v146, 128, v144
  v_xor_b32 v147, 192, v144
  v_lshl_add_u32 v148, v237, 4, s35
  v_lshlrev_b32 v233, 1, v237
  v_xor_b32 v233, v233, v238
  v_lshlrev_b32_e64 v236, 8, v237
  v_lshl_add_u32 v8, v233, 4, v236
  v_xor_b32 v9, 128, v8
  v_mov_b32 v88, 0
  v_mov_b32 v89, 0
  v_mov_b32 v90, 0
  v_mov_b32 v91, 0
  v_mov_b32 v92, 0
  v_mov_b32 v93, 0
  v_mov_b32 v94, 0
  v_mov_b32 v95, 0
  v_mov_b32 v96, 0
  v_mov_b32 v97, 0
  v_mov_b32 v98, 0
  v_mov_b32 v99, 0
  v_mov_b32 v100, 0
  v_mov_b32 v101, 0
  v_mov_b32 v102, 0
  v_mov_b32 v103, 0
  v_mov_b32 v104, 0
  v_mov_b32 v105, 0
  v_mov_b32 v106, 0
  v_mov_b32 v107, 0
  v_mov_b32 v108, 0
  v_mov_b32 v109, 0
  v_mov_b32 v110, 0
  v_mov_b32 v111, 0
  s_add_u32 s65, s52, 4096
  s_add_u32 s73, s65, 131072
  s_add_u32 s66, s52, 8192
  s_add_u32 s74, s66, 131072
  s_add_u32 s67, s52, 12288
  s_add_u32 s75, s67, 131072
  s_add_u32 s68, s52, 16384
  s_add_u32 s76, s68, 131072
  s_add_u32 s69, s52, 20480
  s_add_u32 s77, s69, 131072
  s_add_u32 s70, s52, 24576
  s_add_u32 s78, s70, 131072
  s_add_u32 s71, s52, 28672
  s_add_u32 s79, s71, 131072
  s_mov_b32 s39, 0x53800000
  v_bfe_u32 v232, v2, 2, 2
  v_lshl_add_u32 v232, v237, 2, v232
  v_and_b32_e64 v233, 7, v232
  v_bfe_u32 v234, v2, 1, 1
  v_lshl_add_u32 v233, v233, 1, v234
  v_lshlrev_b32_e64 v232, 8, v232
  v_lshl_add_u32 v232, v233, 4, v232
  v_and_b32_e64 v234, 1, v2
  v_lshl_add_u32 v232, v234, 3, v232
  v_xor_b32 v232, s43, v232
  v_add_u32 v14, s35, v232
  v_xor_b32 v15, 32, v14
  v_xor_b32 v16, 64, v14
  v_xor_b32 v17, 96, v14
  v_xor_b32 v18, 128, v14
  v_xor_b32 v19, 160, v14
  v_xor_b32 v20, 192, v14
  v_xor_b32 v21, 224, v14
  v_add_u32 v1, 63488, v8
  v_add_u32 v9, 31744, v9
  v_add_u32 v2, 63488, v9
  buffer_load_dwordx4 v6, s[16:19], s64 offen offset:2048 lds
  buffer_load_dwordx4 v7, s[16:19], s64 offen offset:3072 lds
  s_add_u32 m0, s35, 4096
  s_nop 0
  s_nop 0
  buffer_load_dwordx4 v4, s[16:19], s72 offen offset:0 lds
  buffer_load_dwordx4 v5, s[16:19], s72 offen offset:1024 lds
  buffer_load_dwordx4 v6, s[16:19], s72 offen offset:2048 lds
  buffer_load_dwordx4 v7, s[16:19], s72 offen offset:3072 lds
  v_add_u32_e64 v23, s35, v3
  v_xor_b32 v24, 32768, v23
  v_xor_b32 v25, 65536, v23
  v_xor_b32 v26, 98304, v23
  v_lshlrev_b32 v232, 8, v238
  v_and_b32 v233, 1, v237
  v_lshl_add_u32 v232, v233, 5, v232
  v_lshrrev_b32_e64 v233, 1, v237
  v_lshl_add_u32 v232, v233, 4, v232
  v_add_u32 v22, s43, v232
  s_add_u32 s53, s32, s55
  s_lshl_b32 s40, s28, 13
  s_nop 0
  s_add_u32 s40, s40, 131072
  v_add_u32 v27, s40, v3
  v_cmp_eq_u32 vcc, 0, v238
  v_mov_b32 v232, 0x3f803f80
  s_nop 0
  v_cndmask_b32 v28, 0, v232, vcc
  v_cndmask_b32 v29, 0, v232, vcc
  v_cndmask_b32 v30, 0, v232, vcc
  v_cndmask_b32 v31, 0, v232, vcc
  s_waitcnt vmcnt(13)
  ds_read_b128 v[240:243], v148 offset:24576
  ds_read_b128 v[244:247], v148 offset:24640
  ds_read_b128 v[248:251], v148 offset:24704
  ds_read_b128 v[252:255], v148 offset:24768
  v_lshlrev_b32_e64 v32, 16, v112
  v_and_b32 v33, 0xffff0000, v112
  v_lshlrev_b32_e64 v34, 16, v113
  v_and_b32 v35, 0xffff0000, v113
  v_lshlrev_b32_e64 v36, 16, v114
  v_and_b32 v37, 0xffff0000, v114
  v_lshlrev_b32_e64 v38, 16, v115
  v_and_b32 v39, 0xffff0000, v115
  v_pk_mul_f32 v[32:33], v[32:33], s[36:37]
  v_pk_mul_f32 v[34:35], v[34:35], s[36:37]
  v_pk_mul_f32 v[36:37], v[36:37], s[36:37]
  v_pk_mul_f32 v[38:39], v[38:39], s[36:37]
  v_cvt_pk_bf16_f32 v112, v32, v33
  v_cvt_pk_bf16_f32 v113, v34, v35
  v_cvt_pk_bf16_f32 v114, v36, v37
  v_cvt_pk_bf16_f32 v115, v38, v39
  ds_write_b128 v144, v[112:115] offset:0
  s_waitcnt lgkmcnt(1)
  s_nop 0
  v_xor_b32 v240, 0x80008000, v240
  v_xor_b32 v241, 0x80008000, v241
  v_xor_b32 v242, 0x80008000, v242
  v_xor_b32 v243, 0x80008000, v243
  v_xor_b32 v244, 0x80008000, v244
  v_xor_b32 v245, 0x80008000, v245
  v_xor_b32 v246, 0x80008000, v246
  v_xor_b32 v247, 0x80008000, v247
  v_xor_b32 v248, 0x80008000, v248
  v_xor_b32 v249, 0x80008000, v249
  v_xor_b32 v250, 0x80008000, v250
  v_xor_b32 v251, 0x80008000, v251
  v_xor_b32 v252, 0x80008000, v252
  v_xor_b32 v253, 0x80008000, v253
  v_xor_b32 v254, 0x80008000, v254
  v_xor_b32 v255, 0x80008000, v255
  s_waitcnt vmcnt(12)
  v_lshlrev_b32 v32, 16, v116
  v_and_b32 v33, 0xffff0000, v116
  v_lshlrev_b32_e64 v34, 16, v117
  v_and_b32 v35, 0xffff0000, v117
  v_lshlrev_b32_e64 v36, 16, v118
  v_and_b32 v37, 0xffff0000, v118
  v_lshlrev_b32_e64 v38, 16, v119
  v_and_b32 v39, 0xffff0000, v119
  v_pk_mul_f32 v[32:33], v[32:33], s[36:37]
  v_pk_mul_f32 v[34:35], v[34:35], s[36:37]
  v_pk_mul_f32 v[36:37], v[36:37], s[36:37]
  v_pk_mul_f32 v[38:39], v[38:39], s[36:37]
  v_cvt_pk_bf16_f32 v116, v32, v33
  v_cvt_pk_bf16_f32 v117, v34, v35
  v_cvt_pk_bf16_f32 v118, v36, v37
  v_cvt_pk_bf16_f32 v119, v38, v39
  ds_write_b128 v145, v[116:119] offset:1024
  s_waitcnt vmcnt(11)
  v_lshlrev_b32 v32, 16, v120
  v_and_b32 v33, 0xffff0000, v120
  v_lshlrev_b32_e64 v34, 16, v121
  v_and_b32 v35, 0xffff0000, v121
  v_lshlrev_b32_e64 v36, 16, v122
  v_and_b32 v37, 0xffff0000, v122
  v_lshlrev_b32_e64 v38, 16, v123
  v_and_b32 v39, 0xffff0000, v123
  v_pk_mul_f32 v[32:33], v[32:33], s[36:37]
  v_pk_mul_f32 v[34:35], v[34:35], s[36:37]
  v_pk_mul_f32 v[36:37], v[36:37], s[36:37]
  v_pk_mul_f32 v[38:39], v[38:39], s[36:37]
  v_cvt_pk_bf16_f32 v120, v32, v33
  v_cvt_pk_bf16_f32 v121, v34, v35
  v_cvt_pk_bf16_f32 v122, v36, v37
  v_cvt_pk_bf16_f32 v123, v38, v39
  ds_write_b128 v146, v[120:123] offset:2048
  s_waitcnt vmcnt(10)
  v_lshlrev_b32 v32, 16, v124
  v_and_b32 v33, 0xffff0000, v124
  v_lshlrev_b32_e64 v34, 16, v125
  v_and_b32 v35, 0xffff0000, v125
  v_lshlrev_b32_e64 v36, 16, v126
  v_and_b32 v37, 0xffff0000, v126
  v_lshlrev_b32_e64 v38, 16, v127
  v_and_b32 v39, 0xffff0000, v127
  v_pk_mul_f32 v[32:33], v[32:33], s[36:37]
  v_pk_mul_f32 v[34:35], v[34:35], s[36:37]
  v_pk_mul_f32 v[36:37], v[36:37], s[36:37]
  v_pk_mul_f32 v[38:39], v[38:39], s[36:37]
  v_cvt_pk_bf16_f32 v124, v32, v33
  v_cvt_pk_bf16_f32 v125, v34, v35
  v_cvt_pk_bf16_f32 v126, v36, v37
  v_cvt_pk_bf16_f32 v127, v38, v39
  ds_write_b128 v147, v[124:127] offset:3072
  s_waitcnt vmcnt(9)
  v_lshlrev_b32 v32, 16, v128
  v_and_b32 v33, 0xffff0000, v128
  v_lshlrev_b32_e64 v34, 16, v129
  v_and_b32 v35, 0xffff0000, v129
  v_lshlrev_b32_e64 v36, 16, v130
  v_and_b32 v37, 0xffff0000, v130
  v_lshlrev_b32_e64 v38, 16, v131
  v_and_b32 v39, 0xffff0000, v131
  v_pk_mul_f32 v[32:33], v[32:33], s[36:37]
  v_pk_mul_f32 v[34:35], v[34:35], s[36:37]
  v_pk_mul_f32 v[36:37], v[36:37], s[36:37]
  v_pk_mul_f32 v[38:39], v[38:39], s[36:37]
  v_cvt_pk_bf16_f32 v128, v32, v33
  v_cvt_pk_bf16_f32 v129, v34, v35
  v_cvt_pk_bf16_f32 v130, v36, v37
  v_cvt_pk_bf16_f32 v131, v38, v39
  ds_write_b128 v144, v[128:131] offset:4096
  s_waitcnt vmcnt(8)
  v_lshlrev_b32 v32, 16, v132
  v_and_b32 v33, 0xffff0000, v132
  v_lshlrev_b32_e64 v34, 16, v133
  v_and_b32 v35, 0xffff0000, v133
  v_lshlrev_b32_e64 v36, 16, v134
  v_and_b32 v37, 0xffff0000, v134
  v_lshlrev_b32_e64 v38, 16, v135
  v_and_b32 v39, 0xffff0000, v135
  v_pk_mul_f32 v[32:33], v[32:33], s[36:37]
  v_pk_mul_f32 v[34:35], v[34:35], s[36:37]
  v_pk_mul_f32 v[36:37], v[36:37], s[36:37]
  v_pk_mul_f32 v[38:39], v[38:39], s[36:37]
  v_cvt_pk_bf16_f32 v132, v32, v33
  v_cvt_pk_bf16_f32 v133, v34, v35
  v_cvt_pk_bf16_f32 v134, v36, v37
  v_cvt_pk_bf16_f32 v135, v38, v39
  ds_write_b128 v145, v[132:135] offset:5120
  s_add_u32 m0, s35, 16384
  s_nop 0
  s_nop 0
  buffer_load_dwordx4 v8, s[20:23], s64 offen offset:0 lds
  buffer_load_dwordx4 v9, s[20:23], s64 offen offset:1024 lds
  buffer_load_dwordx4 v1, s[20:23], s64 offen offset:2048 lds
  buffer_load_dwordx4 v2, s[20:23], s64 offen offset:3072 lds
  s_add_u32 m0, s35, 20480
  s_nop 0
  s_nop 0
  buffer_load_dwordx4 v8, s[20:23], s72 offen offset:0 lds
  buffer_load_dwordx4 v9, s[20:23], s72 offen offset:1024 lds
  buffer_load_dwordx4 v1, s[20:23], s72 offen offset:2048 lds
  buffer_load_dwordx4 v2, s[20:23], s72 offen offset:3072 lds
  s_waitcnt lgkmcnt(0)
  s_barrier
  s_cmp_eq_u32 s38, 1
  s_cbranch_scc1 L_maxpass
L_main:
  ds_read_b128 a[208:211], v140 offset:0
  ds_read_b128 a[212:215], v141 offset:0
  ds_read_b128 a[216:219], v142 offset:0
  ds_read_b128 a[220:223], v143 offset:0
  ds_read_b128 a[224:227], v140 offset:4096
  ds_read_b128 a[228:231], v141 offset:4096
  ds_read_b128 a[232:235], v142 offset:4096
  ds_read_b128 a[236:239], v143 offset:4096
  s_waitcnt vmcnt(8)
  s_nop 0
  ds_read_b128 a[144:147], v10 offset:0
  ds_read_b128 a[148:151], v11 offset:0
  ds_read_b128 a[152:155], v12 offset:0
  ds_read_b128 a[156:159], v13 offset:0
  ds_read_b128 a[160:163], v10 offset:4096
  ds_read_b128 a[164:167], v11 offset:4096
  s_waitcnt lgkmcnt(10)
  s_nop 0
  v_mfma_f32_16x16x32_bf16 v[100:103], v[240:243], a[208:211], v[100:103]
  ds_read_b128 a[168:171], v12 offset:4096
  ds_read_b128 a[172:175], v13 offset:4096
  v_mfma_f32_16x16x32_bf16 v[100:103], v[244:247], a[212:215], v[100:103]
  ds_read_b128 a[240:243], v140 offset:8192
  ds_read_b128 a[244:247], v141 offset:8192
  v_mfma_f32_16x16x32_bf16 v[100:103], v[248:251], a[216:219], v[100:103]
  ds_read_b128 a[248:251], v142 offset:8192
  ds_read_b128 a[252:255], v143 offset:8192
  v_mfma_f32_16x16x32_bf16 v[100:103], v[252:255], a[220:223], v[100:103]
  s_waitcnt lgkmcnt(12)
  s_nop 0
  v_mfma_f32_16x16x32_bf16 v[104:107], v[240:243], a[224:227], v[104:107]
  ds_read_b128 v[184:187], v136 offset:0
  ds_read_b128 v[188:191], v137 offset:0
  v_mfma_f32_16x16x32_bf16 v[104:107], v[244:247], a[228:231], v[104:107]
  ds_read_b128 v[192:195], v138 offset:0
  ds_read_b128 v[196:199], v139 offset:0
  v_mfma_f32_16x16x32_bf16 v[104:107], v[248:251], a[232:235], v[104:107]
  ds_read_b128 v[200:203], v136 offset:4096
  ds_read_b128 v[204:207], v137 offset:4096
  v_mfma_f32_16x16x32_bf16 v[104:107], v[252:255], a[236:239], v[104:107]
  s_waitcnt lgkmcnt(10)
  s_nop 0
  v_mfma_f32_16x16x32_bf16 v[32:35], a[144:147], a[208:211], v[100:103]
  ds_read_b128 v[208:211], v138 offset:4096
  ds_read_b128 v[212:215], v139 offset:4096
  v_mfma_f32_16x16x32_bf16 v[32:35], a[148:151], a[212:215], v[32:35]
  ds_read_b128 v[216:219], v136 offset:8192
  ds_read_b128 v[220:223], v137 offset:8192
  v_mfma_f32_16x16x32_bf16 v[32:35], a[152:155], a[216:219], v[32:35]
  ds_read_b128 v[224:227], v138 offset:8192
  ds_read_b128 v[228:231], v139 offset:8192
  v_mfma_f32_16x16x32_bf16 v[32:35], a[156:159], a[220:223], v[32:35]
  s_add_u32 m0, s35, 8192
  v_mfma_f32_16x16x32_bf16 v[36:39], a[160:163], a[208:211], v[100:103]
  buffer_load_dwordx4 v4, s[16:19], s65 offen offset:0 lds
  v_mfma_f32_16x16x32_bf16 v[36:39], a[164:167], a[212:215], v[36:39]
  buffer_load_dwordx4 v5, s[16:19], s65 offen offset:1024 lds
  v_mfma_f32_16x16x32_bf16 v[36:39], a[168:171], a[216:219], v[36:39]
  v_exp_f32_e64 v32, v32
  v_mfma_f32_16x16x32_bf16 v[36:39], a[172:175], a[220:223], v[36:39]
  buffer_load_dwordx4 v6, s[16:19], s65 offen offset:2048 lds
  v_mfma_f32_16x16x32_bf16 v[40:43], a[144:147], a[224:227], v[104:107]
  v_exp_f32_e64 v33, v33
  v_mfma_f32_16x16x32_bf16 v[40:43], a[148:151], a[228:231], v[40:43]
  buffer_load_dwordx4 v7, s[16:19], s65 offen offset:3072 lds
  v_mfma_f32_16x16x32_bf16 v[40:43], a[152:155], a[232:235], v[40:43]
  s_add_u32 m0, s35, 12288
  v_cvt_pk_bf16_f32 v64, v32, v33
  v_mfma_f32_16x16x32_bf16 v[40:43], a[156:159], a[236:239], v[40:43]
  buffer_load_dwordx4 v4, s[16:19], s73 offen offset:0 lds
  v_mfma_f32_16x16x32_bf16 v[44:47], a[160:163], a[224:227], v[104:107]
  v_exp_f32_e64 v34, v34
  v_mfma_f32_16x16x32_bf16 v[44:47], a[164:167], a[228:231], v[44:47]
  buffer_load_dwordx4 v5, s[16:19], s73 offen offset:1024 lds
  v_mfma_f32_16x16x32_bf16 v[44:47], a[168:171], a[232:235], v[44:47]
  v_exp_f32_e64 v35, v35
  v_mfma_f32_16x16x32_bf16 v[44:47], a[172:175], a[236:239], v[44:47]
  s_waitcnt lgkmcnt(0)
  s_nop 0
  v_mfma_f32_16x16x32_bf16 v[108:111], v[240:243], a[240:243], v[108:111]
  buffer_load_dwordx4 v6, s[16:19], s73 offen offset:2048 lds
  v_mfma_f32_16x16x32_bf16 v[108:111], v[244:247], a[244:247], v[108:111]
  buffer_load_dwordx4 v7, s[16:19], s73 offen offset:3072 lds
  v_mfma_f32_16x16x32_bf16 v[108:111], v[248:251], a[248:251], v[108:111]
  v_exp_f32_e64 v36, v36
  v_mfma_f32_16x16x32_bf16 v[108:111], v[252:255], a[252:255], v[108:111]
  s_add_u32 m0, s35, 24576
  v_cvt_pk_bf16_f32 v65, v34, v35
  v_mfma_f32_16x16x32_bf16 v[88:91], v[240:243], v[184:187], v[88:91]
  buffer_load_dwordx4 v8, s[20:23], s65 offen offset:0 lds
  v_mfma_f32_16x16x32_bf16 v[88:91], v[244:247], v[188:191], v[88:91]
  v_exp_f32_e64 v37, v37
  v_mfma_f32_16x16x32_bf16 v[88:91], v[248:251], v[192:195], v[88:91]
  v_exp_f32_e64 v38, v38
  v_mfma_f32_16x16x32_bf16 v[88:91], v[252:255], v[196:199], v[88:91]
  buffer_load_dwordx4 v9, s[20:23], s65 offen offset:1024 lds
  v_mfma_f32_16x16x32_bf16 v[48:51], a[144:147], a[240:243], v[108:111]
  v_exp_f32_e64 v39, v39
  v_mfma_f32_16x16x32_bf16 v[48:51], a[148:151], a[244:247], v[48:51]
  v_exp_f32_e64 v40, v40
  v_mfma_f32_16x16x32_bf16 v[48:51], a[152:155], a[248:251], v[48:51]
  v_exp_f32_e64 v41, v41
  v_mfma_f32_16x16x32_bf16 v[48:51], a[156:159], a[252:255], v[48:51]
  buffer_load_dwordx4 v1, s[20:23], s65 offen offset:2048 lds
  v_mfma_f32_16x16x32_bf16 v[52:55], a[160:163], a[240:243], v[108:111]
  v_cvt_pk_bf16_f32 v66, v36, v37
  v_cvt_pk_bf16_f32 v67, v38, v39
  v_mfma_f32_16x16x32_bf16 v[52:55], a[164:167], a[244:247], v[52:55]
  v_exp_f32_e64 v42, v42
  v_mfma_f32_16x16x32_bf16 v[52:55], a[168:171], a[248:251], v[52:55]
  v_exp_f32_e64 v43, v43
  v_mfma_f32_16x16x32_bf16 v[52:55], a[172:175], a[252:255], v[52:55]
  v_exp_f32_e64 v44, v44
  v_mfma_f32_16x16x32_bf16 v[56:59], a[144:147], v[184:187], v[88:91]
  buffer_load_dwordx4 v2, s[20:23], s65 offen offset:3072 lds
  v_mfma_f32_16x16x32_bf16 v[56:59], a[148:151], v[188:191], v[56:59]
  v_exp_f32_e64 v45, v45
  v_mfma_f32_16x16x32_bf16 v[56:59], a[152:155], v[192:195], v[56:59]
  v_cvt_pk_bf16_f32 v68, v40, v41
  v_cvt_pk_bf16_f32 v69, v42, v43
  v_mfma_f32_16x16x32_bf16 v[56:59], a[156:159], v[196:199], v[56:59]
  s_add_u32 m0, s35, 28672
  v_cvt_pk_bf16_f32 v70, v44, v45
  v_mfma_f32_16x16x32_bf16 v[60:63], a[160:163], v[184:187], v[88:91]
  buffer_load_dwordx4 v8, s[20:23], s73 offen offset:0 lds
  v_mfma_f32_16x16x32_bf16 v[60:63], a[164:167], v[188:191], v[60:63]
  v_exp_f32_e64 v46, v46
  v_mfma_f32_16x16x32_bf16 v[60:63], a[168:171], v[192:195], v[60:63]
  v_exp_f32_e64 v47, v47
  v_mfma_f32_16x16x32_bf16 v[60:63], a[172:175], v[196:199], v[60:63]
  v_exp_f32_e64 v48, v48
  v_mfma_f32_16x16x32_bf16 v[92:95], v[240:243], v[200:203], v[92:95]
  buffer_load_dwordx4 v9, s[20:23], s73 offen offset:1024 lds
  v_mfma_f32_16x16x32_bf16 v[92:95], v[244:247], v[204:207], v[92:95]
  v_exp_f32_e64 v49, v49
  v_mfma_f32_16x16x32_bf16 v[92:95], v[248:251], v[208:211], v[92:95]
  v_exp_f32_e64 v50, v50
  v_mfma_f32_16x16x32_bf16 v[92:95], v[252:255], v[212:215], v[92:95]
  s_waitcnt vmcnt(14)
  s_nop 0
  v_mfma_f32_16x16x32_bf16 v[96:99], v[240:243], v[216:219], v[96:99]
  ds_read_b64_tr_b16 a[176:177], v14 offset:16384
  ds_read_b64_tr_b16 a[178:179], v14 offset:20480
  v_mfma_f32_16x16x32_bf16 v[96:99], v[244:247], v[220:223], v[96:99]
  buffer_load_dwordx4 v1, s[20:23], s73 offen offset:2048 lds
  v_mfma_f32_16x16x32_bf16 v[96:99], v[248:251], v[224:227], v[96:99]
  ds_read_b64_tr_b16 a[180:181], v15 offset:16384
  ds_read_b64_tr_b16 a[182:183], v15 offset:20480
  v_mfma_f32_16x16x32_bf16 v[96:99], v[252:255], v[228:231], v[96:99]
  v_exp_f32_e64 v51, v51
  v_mfma_f32_16x16x32_bf16 v[32:35], a[144:147], v[200:203], v[92:95]
  ds_read_b64_tr_b16 a[184:185], v16 offset:16384
  ds_read_b64_tr_b16 a[186:187], v16 offset:20480
  v_mfma_f32_16x16x32_bf16 v[32:35], a[148:151], v[204:207], v[32:35]
  buffer_load_dwordx4 v2, s[20:23], s73 offen offset:3072 lds
  v_mfma_f32_16x16x32_bf16 v[32:35], a[152:155], v[208:211], v[32:35]
  ds_read_b64_tr_b16 a[188:189], v17 offset:16384
  ds_read_b64_tr_b16 a[190:191], v17 offset:20480
  v_mfma_f32_16x16x32_bf16 v[32:35], a[156:159], v[212:215], v[32:35]
  v_cvt_pk_bf16_f32 v71, v46, v47
  v_cvt_pk_bf16_f32 v72, v48, v49
  v_mfma_f32_16x16x32_bf16 v[36:39], a[160:163], v[200:203], v[92:95]
  ds_read_b64_tr_b16 a[192:193], v18 offset:16384
  ds_read_b64_tr_b16 a[194:195], v18 offset:20480
  v_mfma_f32_16x16x32_bf16 v[36:39], a[164:167], v[204:207], v[36:39]
  v_exp_f32_e64 v52, v52
  v_mfma_f32_16x16x32_bf16 v[36:39], a[168:171], v[208:211], v[36:39]
  ds_read_b64_tr_b16 a[196:197], v19 offset:16384
  ds_read_b64_tr_b16 a[198:199], v19 offset:20480
  v_mfma_f32_16x16x32_bf16 v[36:39], a[172:175], v[212:215], v[36:39]
  v_exp_f32_e64 v53, v53
  v_mfma_f32_16x16x32_bf16 v[40:43], a[144:147], v[216:219], v[96:99]
  ds_read_b64_tr_b16 a[200:201], v20 offset:16384
  ds_read_b64_tr_b16 a[202:203], v20 offset:20480
  v_mfma_f32_16x16x32_bf16 v[40:43], a[148:151], v[220:223], v[40:43]
  v_exp_f32_e64 v54, v54
  v_mfma_f32_16x16x32_bf16 v[40:43], a[152:155], v[224:227], v[40:43]
  ds_read_b64_tr_b16 a[204:205], v21 offset:16384
  ds_read_b64_tr_b16 a[206:207], v21 offset:20480
  v_mfma_f32_16x16x32_bf16 v[40:43], a[156:159], v[228:231], v[40:43]
  s_add_u32 m0, s35, 0
  s_nop 0
  v_cvt_pk_bf16_f32 v73, v50, v51
  v_mfma_f32_16x16x32_bf16 v[44:47], a[160:163], v[216:219], v[96:99]
  buffer_load_dwordx4 v4, s[16:19], s66 offen offset:0 lds
  v_mfma_f32_16x16x32_bf16 v[44:47], a[164:167], v[220:223], v[44:47]
  s_waitcnt vmcnt(9)
  s_nop 0
  v_mfma_f32_16x16x32_bf16 v[44:47], a[168:171], v[224:227], v[44:47]
  ds_read_b128 a[144:147], v10 offset:8192
  ds_read_b128 a[148:151], v11 offset:8192
  v_mfma_f32_16x16x32_bf16 v[44:47], a[172:175], v[228:231], v[44:47]
  s_waitcnt lgkmcnt(10)
  s_nop 0
  v_mfma_f32_16x16x32_bf16 a[48:51], a[176:179], v[64:67], 0
  buffer_load_dwordx4 v5, s[16:19], s66 offen offset:1024 lds
  v_mfma_f32_16x16x32_bf16 a[64:67], a[176:179], v[68:71], 0
  buffer_load_dwordx4 v6, s[16:19], s66 offen offset:2048 lds
  v_mfma_f32_16x16x32_bf16 a[52:55], a[180:183], v[64:67], 0
  ds_read_b128 a[152:155], v12 offset:8192
  ds_read_b128 a[156:159], v13 offset:8192
  v_mfma_f32_16x16x32_bf16 a[68:71], a[180:183], v[68:71], 0
  buffer_load_dwordx4 v7, s[16:19], s66 offen offset:3072 lds
  v_mfma_f32_16x16x32_bf16 a[56:59], a[184:187], v[64:67], 0
  v_exp_f32_e64 v55, v55
  v_mfma_f32_16x16x32_bf16 a[72:75], a[184:187], v[68:71], 0
  s_waitcnt lgkmcnt(4)
  s_nop 0
  v_mfma_f32_16x16x32_bf16 a[60:63], a[188:191], v[64:67], 0
  ds_read_b128 a[160:163], v10 offset:12288
  ds_read_b128 a[164:167], v11 offset:12288
  v_mfma_f32_16x16x32_bf16 a[76:79], a[188:191], v[68:71], 0
  s_add_u32 m0, s35, 4096
  v_cvt_pk_bf16_f32 v74, v52, v53
  v_mfma_f32_16x16x32_bf16 a[96:99], a[192:195], v[64:67], 0
  buffer_load_dwordx4 v4, s[16:19], s74 offen offset:0 lds
  v_mfma_f32_16x16x32_bf16 a[112:115], a[192:195], v[68:71], 0
  buffer_load_dwordx4 v5, s[16:19], s74 offen offset:1024 lds
  v_mfma_f32_16x16x32_bf16 a[100:103], a[196:199], v[64:67], 0
  ds_read_b128 a[168:171], v12 offset:12288
  ds_read_b128 a[172:175], v13 offset:12288
  v_mfma_f32_16x16x32_bf16 a[116:119], a[196:199], v[68:71], 0
  v_exp_f32_e64 v56, v56
  v_mfma_f32_16x16x32_bf16 a[104:107], a[200:203], v[64:67], 0
  v_exp_f32_e64 v57, v57
  v_mfma_f32_16x16x32_bf16 a[120:123], a[200:203], v[68:71], 0
  v_exp_f32_e64 v58, v58
  v_mfma_f32_16x16x32_bf16 a[108:111], a[204:207], v[64:67], 0
  buffer_load_dwordx4 v6, s[16:19], s74 offen offset:2048 lds
  v_mfma_f32_16x16x32_bf16 a[124:127], a[204:207], v[68:71], 0
  v_exp_f32_e64 v59, v59
  v_mfma_f32_16x16x32_bf16 v[124:127], v[28:31], v[64:67], 0
  v_cvt_pk_bf16_f32 v75, v54, v55
  v_cvt_pk_bf16_f32 v76, v56, v57
  v_mfma_f32_16x16x32_bf16 v[128:131], v[28:31], v[68:71], 0
  s_waitcnt lgkmcnt(0)
  s_nop 0
  v_mfma_f32_16x16x32_bf16 v[48:51], a[144:147], a[208:211], v[100:103]
  buffer_load_dwordx4 v7, s[16:19], s74 offen offset:3072 lds
  v_mfma_f32_16x16x32_bf16 v[48:51], a[148:151], a[212:215], v[48:51]
  v_exp_f32_e64 v60, v60
  v_mfma_f32_16x16x32_bf16 v[48:51], a[152:155], a[216:219], v[48:51]
  v_exp_f32_e64 v61, v61
  v_mfma_f32_16x16x32_bf16 v[48:51], a[156:159], a[220:223], v[48:51]
  v_cvt_pk_bf16_f32 v77, v58, v59
  v_cvt_pk_bf16_f32 v78, v60, v61
  v_mfma_f32_16x16x32_bf16 v[52:55], a[160:163], a[208:211], v[100:103]
  v_exp_f32_e64 v62, v62
  v_mfma_f32_16x16x32_bf16 v[52:55], a[164:167], a[212:215], v[52:55]
  s_add_u32 m0, s35, 16384
  v_mfma_f32_16x16x32_bf16 v[52:55], a[168:171], a[216:219], v[52:55]
  buffer_load_dwordx4 v8, s[20:23], s66 offen offset:0 lds
  v_mfma_f32_16x16x32_bf16 v[52:55], a[172:175], a[220:223], v[52:55]
  v_exp_f32_e64 v63, v63
  v_mfma_f32_16x16x32_bf16 v[56:59], a[144:147], a[224:227], v[104:107]
  v_exp_f32_e64 v32, v32
  v_mfma_f32_16x16x32_bf16 v[56:59], a[148:151], a[228:231], v[56:59]
  v_exp_f32_e64 v33, v33
  v_mfma_f32_16x16x32_bf16 v[56:59], a[152:155], a[232:235], v[56:59]
  v_cvt_pk_bf16_f32 v79, v62, v63
  v_cvt_pk_bf16_f32 v80, v32, v33
  v_mfma_f32_16x16x32_bf16 v[56:59], a[156:159], a[236:239], v[56:59]
  buffer_load_dwordx4 v9, s[20:23], s66 offen offset:1024 lds
  v_mfma_f32_16x16x32_bf16 v[60:63], a[160:163], a[224:227], v[104:107]
  v_exp_f32_e64 v34, v34
  v_mfma_f32_16x16x32_bf16 v[60:63], a[164:167], a[228:231], v[60:63]
  v_exp_f32_e64 v35, v35
  v_mfma_f32_16x16x32_bf16 v[60:63], a[168:171], a[232:235], v[60:63]
  v_exp_f32_e64 v36, v36
  v_mfma_f32_16x16x32_bf16 v[60:63], a[172:175], a[236:239], v[60:63]
  v_exp_f32_e64 v37, v37
  v_mfma_f32_16x16x32_bf16 a[80:83], a[176:179], v[72:75], 0
  v_exp_f32_e64 v38, v38
  v_mfma_f32_16x16x32_bf16 v[136:139], a[176:179], v[76:79], 0
  buffer_load_dwordx4 v1, s[20:23], s66 offen offset:2048 lds
  v_mfma_f32_16x16x32_bf16 a[84:87], a[180:183], v[72:75], 0
  v_exp_f32_e64 v39, v39
  v_mfma_f32_16x16x32_bf16 v[140:143], a[180:183], v[76:79], 0
  v_cvt_pk_bf16_f32 v81, v34, v35
  v_cvt_pk_bf16_f32 v82, v36, v37
  v_mfma_f32_16x16x32_bf16 a[88:91], a[184:187], v[72:75], 0
  v_exp_f32_e64 v40, v40
  v_mfma_f32_16x16x32_bf16 v[144:147], a[184:187], v[76:79], 0
  v_exp_f32_e64 v41, v41
  v_mfma_f32_16x16x32_bf16 a[92:95], a[188:191], v[72:75], 0
  v_exp_f32_e64 v42, v42
  v_mfma_f32_16x16x32_bf16 v[148:151], a[188:191], v[76:79], 0
  buffer_load_dwordx4 v2, s[20:23], s66 offen offset:3072 lds
  v_mfma_f32_16x16x32_bf16 a[128:131], a[192:195], v[72:75], 0
  v_exp_f32_e64 v43, v43
  v_mfma_f32_16x16x32_bf16 a[0:3], a[192:195], v[76:79], 0
  v_cvt_pk_bf16_f32 v83, v38, v39
  v_cvt_pk_bf16_f32 v84, v40, v41
  v_mfma_f32_16x16x32_bf16 a[132:135], a[196:199], v[72:75], 0
  v_exp_f32_e64 v44, v44
  v_mfma_f32_16x16x32_bf16 a[4:7], a[196:199], v[76:79], 0
  v_exp_f32_e64 v45, v45
  v_mfma_f32_16x16x32_bf16 a[136:139], a[200:203], v[72:75], 0
  s_add_u32 m0, s35, 20480
  v_cvt_pk_bf16_f32 v85, v42, v43
  v_mfma_f32_16x16x32_bf16 a[8:11], a[200:203], v[76:79], 0
  buffer_load_dwordx4 v8, s[20:23], s74 offen offset:0 lds
  v_mfma_f32_16x16x32_bf16 a[140:143], a[204:207], v[72:75], 0
  v_exp_f32_e64 v46, v46
  v_mfma_f32_16x16x32_bf16 a[12:15], a[204:207], v[76:79], 0
  v_exp_f32_e64 v47, v47
  v_mfma_f32_16x16x32_bf16 v[132:135], v[28:31], v[72:75], 0
  v_exp_f32_e64 v48, v48
  v_mfma_f32_16x16x32_bf16 v[112:115], v[28:31], v[76:79], 0
  v_exp_f32_e64 v49, v49
  v_mfma_f32_16x16x32_bf16 v[32:35], a[144:147], a[240:243], v[108:111]
  v_cvt_pk_bf16_f32 v86, v44, v45
  v_cvt_pk_bf16_f32 v87, v46, v47
  v_mfma_f32_16x16x32_bf16 v[32:35], a[148:151], a[244:247], v[32:35]
  buffer_load_dwordx4 v9, s[20:23], s74 offen offset:1024 lds
  v_mfma_f32_16x16x32_bf16 v[32:35], a[152:155], a[248:251], v[32:35]
  v_exp_f32_e64 v50, v50
  v_mfma_f32_16x16x32_bf16 v[32:35], a[156:159], a[252:255], v[32:35]
  v_exp_f32_e64 v51, v51
  v_mfma_f32_16x16x32_bf16 v[36:39], a[160:163], a[240:243], v[108:111]
  v_exp_f32_e64 v52, v52
  v_mfma_f32_16x16x32_bf16 v[36:39], a[164:167], a[244:247], v[36:39]
  v_exp_f32_e64 v53, v53
  v_mfma_f32_16x16x32_bf16 v[36:39], a[168:171], a[248:251], v[36:39]
  v_cvt_pk_bf16_f32 v64, v48, v49
  v_cvt_pk_bf16_f32 v65, v50, v51
  v_mfma_f32_16x16x32_bf16 v[36:39], a[172:175], a[252:255], v[36:39]
  buffer_load_dwordx4 v1, s[20:23], s74 offen offset:2048 lds
  v_mfma_f32_16x16x32_bf16 v[40:43], a[144:147], v[184:187], v[88:91]
  v_exp_f32_e64 v54, v54
  v_mfma_f32_16x16x32_bf16 v[40:43], a[148:151], v[188:191], v[40:43]
  v_exp_f32_e64 v55, v55
  v_mfma_f32_16x16x32_bf16 v[40:43], a[152:155], v[192:195], v[40:43]
  v_exp_f32_e64 v56, v56
  v_mfma_f32_16x16x32_bf16 v[40:43], a[156:159], v[196:199], v[40:43]
  v_exp_f32_e64 v57, v57
  v_mfma_f32_16x16x32_bf16 v[44:47], a[160:163], v[184:187], v[88:91]
  v_cvt_pk_bf16_f32 v66, v52, v53
  v_cvt_pk_bf16_f32 v67, v54, v55
  v_mfma_f32_16x16x32_bf16 v[44:47], a[164:167], v[188:191], v[44:47]
  buffer_load_dwordx4 v2, s[20:23], s74 offen offset:3072 lds
  v_mfma_f32_16x16x32_bf16 v[44:47], a[168:171], v[192:195], v[44:47]
  v_exp_f32_e64 v58, v58
  v_mfma_f32_16x16x32_bf16 v[44:47], a[172:175], v[196:199], v[44:47]
  s_add_u32 m0, s35, 8192
  v_cvt_pk_bf16_f32 v68, v56, v57
  v_mfma_f32_16x16x32_bf16 v[152:155], a[176:179], v[80:83], 0
  buffer_load_dwordx4 v4, s[16:19], s67 offen offset:0 lds
  v_mfma_f32_16x16x32_bf16 v[168:171], a[176:179], v[84:87], 0
  v_exp_f32_e64 v59, v59
  v_mfma_f32_16x16x32_bf16 v[156:159], a[180:183], v[80:83], 0
  v_exp_f32_e64 v60, v60
  v_mfma_f32_16x16x32_bf16 v[172:175], a[180:183], v[84:87], 0
  v_exp_f32_e64 v61, v61
  v_mfma_f32_16x16x32_bf16 v[160:163], a[184:187], v[80:83], 0
  v_exp_f32_e64 v62, v62
  v_mfma_f32_16x16x32_bf16 v[176:179], a[184:187], v[84:87], 0
  buffer_load_dwordx4 v5, s[16:19], s67 offen offset:1024 lds
  v_mfma_f32_16x16x32_bf16 v[164:167], a[188:191], v[80:83], 0
  v_exp_f32_e64 v63, v63
  v_mfma_f32_16x16x32_bf16 v[180:183], a[188:191], v[84:87], 0
  v_cvt_pk_bf16_f32 v69, v58, v59
  v_cvt_pk_bf16_f32 v70, v60, v61
  v_mfma_f32_16x16x32_bf16 a[16:19], a[192:195], v[80:83], 0
  v_exp_f32_e64 v32, v32
  v_mfma_f32_16x16x32_bf16 a[32:35], a[192:195], v[84:87], 0
  v_exp_f32_e64 v33, v33
  v_mfma_f32_16x16x32_bf16 a[20:23], a[196:199], v[80:83], 0
  v_exp_f32_e64 v34, v34
  v_mfma_f32_16x16x32_bf16 a[36:39], a[196:199], v[84:87], 0
  buffer_load_dwordx4 v6, s[16:19], s67 offen offset:2048 lds
  v_mfma_f32_16x16x32_bf16 a[24:27], a[200:203], v[80:83], 0
  v_exp_f32_e64 v35, v35
  v_mfma_f32_16x16x32_bf16 a[40:43], a[200:203], v[84:87], 0
  s_waitcnt vmcnt(19)
  s_nop 0
  v_mfma_f32_16x16x32_bf16 a[28:31], a[204:207], v[80:83], 0
  ds_read_b64_tr_b16 a[176:177], v14 offset:24576
  ds_read_b64_tr_b16 a[178:179], v14 offset:28672
  v_mfma_f32_16x16x32_bf16 a[44:47], a[204:207], v[84:87], 0
  v_cvt_pk_bf16_f32 v71, v62, v63
  v_cvt_pk_bf16_f32 v72, v32, v33
  v_mfma_f32_16x16x32_bf16 v[116:119], v[28:31], v[80:83], 0
  ds_read_b64_tr_b16 a[180:181], v15 offset:24576
  ds_read_b64_tr_b16 a[182:183], v15 offset:28672
  v_mfma_f32_16x16x32_bf16 v[120:123], v[28:31], v[84:87], 0
  buffer_load_dwordx4 v7, s[16:19], s67 offen offset:3072 lds
  v_mfma_f32_16x16x32_bf16 v[48:51], a[144:147], v[200:203], v[92:95]
  ds_read_b64_tr_b16 a[184:185], v16 offset:24576
  ds_read_b64_tr_b16 a[186:187], v16 offset:28672
  v_mfma_f32_16x16x32_bf16 v[48:51], a[148:151], v[204:207], v[48:51]
  v_exp_f32_e64 v36, v36
  v_mfma_f32_16x16x32_bf16 v[48:51], a[152:155], v[208:211], v[48:51]
  ds_read_b64_tr_b16 a[188:189], v17 offset:24576
  ds_read_b64_tr_b16 a[190:191], v17 offset:28672
  v_mfma_f32_16x16x32_bf16 v[48:51], a[156:159], v[212:215], v[48:51]
  v_exp_f32_e64 v37, v37
  v_mfma_f32_16x16x32_bf16 v[52:55], a[160:163], v[200:203], v[92:95]
  ds_read_b64_tr_b16 a[192:193], v18 offset:24576
  ds_read_b64_tr_b16 a[194:195], v18 offset:28672
  v_mfma_f32_16x16x32_bf16 v[52:55], a[164:167], v[204:207], v[52:55]
  v_exp_f32_e64 v38, v38
  v_mfma_f32_16x16x32_bf16 v[52:55], a[168:171], v[208:211], v[52:55]
  ds_read_b64_tr_b16 a[196:197], v19 offset:24576
  ds_read_b64_tr_b16 a[198:199], v19 offset:28672
  v_mfma_f32_16x16x32_bf16 v[52:55], a[172:175], v[212:215], v[52:55]
  v_exp_f32_e64 v39, v39
  v_mfma_f32_16x16x32_bf16 v[56:59], a[144:147], v[216:219], v[96:99]
  ds_read_b64_tr_b16 a[200:201], v20 offset:24576
  ds_read_b64_tr_b16 a[202:203], v20 offset:28672
  v_mfma_f32_16x16x32_bf16 v[56:59], a[148:151], v[220:223], v[56:59]
  v_cvt_pk_bf16_f32 v73, v34, v35
  v_cvt_pk_bf16_f32 v74, v36, v37
  v_mfma_f32_16x16x32_bf16 v[56:59], a[152:155], v[224:227], v[56:59]
  ds_read_b64_tr_b16 a[204:205], v21 offset:24576
  ds_read_b64_tr_b16 a[206:207], v21 offset:28672
  v_mfma_f32_16x16x32_bf16 v[56:59], a[156:159], v[228:231], v[56:59]
  s_add_u32 m0, s35, 12288
  v_cvt_pk_bf16_f32 v75, v38, v39
  v_mfma_f32_16x16x32_bf16 v[60:63], a[160:163], v[216:219], v[96:99]
  buffer_load_dwordx4 v4, s[16:19], s75 offen offset:0 lds
  v_mfma_f32_16x16x32_bf16 v[60:63], a[164:167], v[220:223], v[60:63]
  s_waitcnt vmcnt(13)
  s_nop 0
  v_mfma_f32_16x16x32_bf16 v[60:63], a[168:171], v[224:227], v[60:63]
  ds_read_b128 a[144:147], v10 offset:0
  ds_read_b128 a[148:151], v11 offset:0
  v_mfma_f32_16x16x32_bf16 v[60:63], a[172:175], v[228:231], v[60:63]
  s_waitcnt lgkmcnt(10)
  s_nop 0
  v_mfma_f32_16x16x32_bf16 a[48:51], a[176:179], v[64:67], a[48:51]
  buffer_load_dwordx4 v5, s[16:19], s75 offen offset:1024 lds
  v_mfma_f32_16x16x32_bf16 a[64:67], a[176:179], v[68:71], a[64:67]
  buffer_load_dwordx4 v6, s[16:19], s75 offen offset:2048 lds
  v_mfma_f32_16x16x32_bf16 a[52:55], a[180:183], v[64:67], a[52:55]
  ds_read_b128 a[152:155], v12 offset:0
  ds_read_b128 a[156:159], v13 offset:0
  v_mfma_f32_16x16x32_bf16 a[68:71], a[180:183], v[68:71], a[68:71]
  v_exp_f32_e64 v40, v40
  v_mfma_f32_16x16x32_bf16 a[56:59], a[184:187], v[64:67], a[56:59]
  v_exp_f32_e64 v41, v41
  v_mfma_f32_16x16x32_bf16 a[72:75], a[184:187], v[68:71], a[72:75]
  s_waitcnt lgkmcnt(4)
  s_nop 0
  v_mfma_f32_16x16x32_bf16 a[60:63], a[188:191], v[64:67], a[60:63]
  ds_read_b128 a[160:163], v10 offset:4096
  ds_read_b128 a[164:167], v11 offset:4096
  v_mfma_f32_16x16x32_bf16 a[76:79], a[188:191], v[68:71], a[76:79]
  buffer_load_dwordx4 v7, s[16:19], s75 offen offset:3072 lds
  v_mfma_f32_16x16x32_bf16 a[96:99], a[192:195], v[64:67], a[96:99]
  v_exp_f32_e64 v42, v42
  v_mfma_f32_16x16x32_bf16 a[112:115], a[192:195], v[68:71], a[112:115]
  v_exp_f32_e64 v43, v43
  v_mfma_f32_16x16x32_bf16 a[100:103], a[196:199], v[64:67], a[100:103]
  ds_read_b128 a[168:171], v12 offset:4096
  ds_read_b128 a[172:175], v13 offset:4096
  v_mfma_f32_16x16x32_bf16 a[116:119], a[196:199], v[68:71], a[116:119]
  v_exp_f32_e64 v44, v44
  v_mfma_f32_16x16x32_bf16 a[104:107], a[200:203], v[64:67], a[104:107]
  v_exp_f32_e64 v45, v45
  v_mfma_f32_16x16x32_bf16 a[120:123], a[200:203], v[68:71], a[120:123]
  v_cvt_pk_bf16_f32 v76, v40, v41
  v_cvt_pk_bf16_f32 v77, v42, v43
  v_mfma_f32_16x16x32_bf16 a[108:111], a[204:207], v[64:67], a[108:111]
  v_exp_f32_e64 v46, v46
  v_mfma_f32_16x16x32_bf16 a[124:127], a[204:207], v[68:71], a[124:127]
  v_exp_f32_e64 v47, v47
  v_mfma_f32_16x16x32_bf16 v[124:127], v[28:31], v[64:67], v[124:127]
  v_exp_f32_e64 v48, v48
  v_mfma_f32_16x16x32_bf16 v[128:131], v[28:31], v[68:71], v[128:131]
  s_waitcnt lgkmcnt(0)
  s_nop 0
  v_mfma_f32_16x16x32_bf16 v[32:35], a[144:147], a[208:211], v[100:103]
  v_exp_f32_e64 v49, v49
  v_mfma_f32_16x16x32_bf16 v[32:35], a[148:151], a[212:215], v[32:35]
  v_cvt_pk_bf16_f32 v78, v44, v45
  v_cvt_pk_bf16_f32 v79, v46, v47
  v_mfma_f32_16x16x32_bf16 v[32:35], a[152:155], a[216:219], v[32:35]
  v_exp_f32_e64 v50, v50
  v_mfma_f32_16x16x32_bf16 v[32:35], a[156:159], a[220:223], v[32:35]
  v_exp_f32_e64 v51, v51
  v_mfma_f32_16x16x32_bf16 v[36:39], a[160:163], a[208:211], v[100:103]
  v_exp_f32_e64 v52, v52
  v_mfma_f32_16x16x32_bf16 v[36:39], a[164:167], a[212:215], v[36:39]
  s_add_u32 m0, s35, 24576
  v_cvt_pk_bf16_f32 v80, v48, v49
  v_mfma_f32_16x16x32_bf16 v[36:39], a[168:171], a[216:219], v[36:39]
  buffer_load_dwordx4 v8, s[20:23], s67 offen offset:0 lds
  v_mfma_f32_16x16x32_bf16 v[36:39], a[172:175], a[220:223], v[36:39]
  v_exp_f32_e64 v53, v53
  v_mfma_f32_16x16x32_bf16 v[40:43], a[144:147], a[224:227], v[104:107]
  v_exp_f32_e64 v54, v54
  v_mfma_f32_16x16x32_bf16 v[40:43], a[148:151], a[228:231], v[40:43]
  v_exp_f32_e64 v55, v55
  v_mfma_f32_16x16x32_bf16 v[40:43], a[152:155], a[232:235], v[40:43]
  v_cvt_pk_bf16_f32 v81, v50, v51
  v_cvt_pk_bf16_f32 v82, v52, v53
  v_mfma_f32_16x16x32_bf16 v[40:43], a[156:159], a[236:239], v[40:43]
  buffer_load_dwordx4 v9, s[20:23], s67 offen offset:1024 lds
  v_mfma_f32_16x16x32_bf16 v[44:47], a[160:163], a[224:227], v[104:107]
  v_exp_f32_e64 v56, v56
  v_mfma_f32_16x16x32_bf16 v[44:47], a[164:167], a[228:231], v[44:47]
  v_exp_f32_e64 v57, v57
  v_mfma_f32_16x16x32_bf16 v[44:47], a[168:171], a[232:235], v[44:47]
  v_exp_f32_e64 v58, v58
  v_mfma_f32_16x16x32_bf16 v[44:47], a[172:175], a[236:239], v[44:47]
  v_exp_f32_e64 v59, v59
  v_mfma_f32_16x16x32_bf16 a[80:83], a[176:179], v[72:75], a[80:83]
  v_cvt_pk_bf16_f32 v83, v54, v55
  v_cvt_pk_bf16_f32 v84, v56, v57
  v_mfma_f32_16x16x32_bf16 v[136:139], a[176:179], v[76:79], v[136:139]
  buffer_load_dwordx4 v1, s[20:23], s67 offen offset:2048 lds
  v_mfma_f32_16x16x32_bf16 a[84:87], a[180:183], v[72:75], a[84:87]
  v_exp_f32_e64 v60, v60
  v_mfma_f32_16x16x32_bf16 v[140:143], a[180:183], v[76:79], v[140:143]
  v_exp_f32_e64 v61, v61
  v_mfma_f32_16x16x32_bf16 a[88:91], a[184:187], v[72:75], a[88:91]
  v_exp_f32_e64 v62, v62
  v_mfma_f32_16x16x32_bf16 v[144:147], a[184:187], v[76:79], v[144:147]
  v_exp_f32_e64 v63, v63
  v_mfma_f32_16x16x32_bf16 a[92:95], a[188:191], v[72:75], a[92:95]
  v_cvt_pk_bf16_f32 v85, v58, v59
  v_cvt_pk_bf16_f32 v86, v60, v61
  v_mfma_f32_16x16x32_bf16 v[148:151], a[188:191], v[76:79], v[148:151]
  buffer_load_dwordx4 v2, s[20:23], s67 offen offset:3072 lds
  v_mfma_f32_16x16x32_bf16 a[128:131], a[192:195], v[72:75], a[128:131]
  v_exp_f32_e64 v32, v32
  v_mfma_f32_16x16x32_bf16 a[0:3], a[192:195], v[76:79], a[0:3]
  v_exp_f32_e64 v33, v33
  v_mfma_f32_16x16x32_bf16 a[132:135], a[196:199], v[72:75], a[132:135]
  v_exp_f32_e64 v34, v34
  v_mfma_f32_16x16x32_bf16 a[4:7], a[196:199], v[76:79], a[4:7]
  v_exp_f32_e64 v35, v35
  v_mfma_f32_16x16x32_bf16 a[136:139], a[200:203], v[72:75], a[136:139]
  s_add_u32 m0, s35, 28672
  v_cvt_pk_bf16_f32 v87, v62, v63
  v_mfma_f32_16x16x32_bf16 a[8:11], a[200:203], v[76:79], a[8:11]
  buffer_load_dwordx4 v8, s[20:23], s75 offen offset:0 lds
  v_mfma_f32_16x16x32_bf16 a[140:143], a[204:207], v[72:75], a[140:143]
  v_exp_f32_e64 v36, v36
  v_mfma_f32_16x16x32_bf16 a[12:15], a[204:207], v[76:79], a[12:15]
  v_exp_f32_e64 v37, v37
  v_mfma_f32_16x16x32_bf16 v[132:135], v[28:31], v[72:75], v[132:135]
  v_cvt_pk_bf16_f32 v64, v32, v33
  v_cvt_pk_bf16_f32 v65, v34, v35
  v_mfma_f32_16x16x32_bf16 v[112:115], v[28:31], v[76:79], v[112:115]
  v_exp_f32_e64 v38, v38
  v_mfma_f32_16x16x32_bf16 v[48:51], a[144:147], a[240:243], v[108:111]
  v_exp_f32_e64 v39, v39
  v_mfma_f32_16x16x32_bf16 v[48:51], a[148:151], a[244:247], v[48:51]
  buffer_load_dwordx4 v9, s[20:23], s75 offen offset:1024 lds
  v_mfma_f32_16x16x32_bf16 v[48:51], a[152:155], a[248:251], v[48:51]
  v_exp_f32_e64 v40, v40
  v_mfma_f32_16x16x32_bf16 v[48:51], a[156:159], a[252:255], v[48:51]
  v_exp_f32_e64 v41, v41
  v_mfma_f32_16x16x32_bf16 v[52:55], a[160:163], a[240:243], v[108:111]
  v_cvt_pk_bf16_f32 v66, v36, v37
  v_cvt_pk_bf16_f32 v67, v38, v39
  v_mfma_f32_16x16x32_bf16 v[52:55], a[164:167], a[244:247], v[52:55]
  v_exp_f32_e64 v42, v42
  v_mfma_f32_16x16x32_bf16 v[52:55], a[168:171], a[248:251], v[52:55]
  v_exp_f32_e64 v43, v43
  v_mfma_f32_16x16x32_bf16 v[52:55], a[172:175], a[252:255], v[52:55]
  buffer_load_dwordx4 v1, s[20:23], s75 offen offset:2048 lds
  v_mfma_f32_16x16x32_bf16 v[56:59], a[144:147], v[184:187], v[88:91]
  v_exp_f32_e64 v44, v44
  v_mfma_f32_16x16x32_bf16 v[56:59], a[148:151], v[188:191], v[56:59]
  v_exp_f32_e64 v45, v45
  v_mfma_f32_16x16x32_bf16 v[56:59], a[152:155], v[192:195], v[56:59]
  v_cvt_pk_bf16_f32 v68, v40, v41
  v_cvt_pk_bf16_f32 v69, v42, v43
  v_mfma_f32_16x16x32_bf16 v[56:59], a[156:159], v[196:199], v[56:59]
  v_exp_f32_e64 v46, v46
  v_mfma_f32_16x16x32_bf16 v[60:63], a[160:163], v[184:187], v[88:91]
  v_exp_f32_e64 v47, v47
  v_mfma_f32_16x16x32_bf16 v[60:63], a[164:167], v[188:191], v[60:63]
  buffer_load_dwordx4 v2, s[20:23], s75 offen offset:3072 lds
  v_mfma_f32_16x16x32_bf16 v[60:63], a[168:171], v[192:195], v[60:63]
  v_exp_f32_e64 v48, v48
  v_mfma_f32_16x16x32_bf16 v[60:63], a[172:175], v[196:199], v[60:63]
  s_add_u32 m0, s35, 0
  s_nop 0
  v_cvt_pk_bf16_f32 v70, v44, v45
  v_mfma_f32_16x16x32_bf16 v[152:155], a[176:179], v[80:83], v[152:155]
  buffer_load_dwordx4 v4, s[16:19], s68 offen offset:0 lds
  v_mfma_f32_16x16x32_bf16 v[168:171], a[176:179], v[84:87], v[168:171]
  v_exp_f32_e64 v49, v49
  v_mfma_f32_16x16x32_bf16 v[156:159], a[180:183], v[80:83], v[156:159]
  v_exp_f32_e64 v50, v50
  v_mfma_f32_16x16x32_bf16 v[172:175], a[180:183], v[84:87], v[172:175]
  v_exp_f32_e64 v51, v51
  v_mfma_f32_16x16x32_bf16 v[160:163], a[184:187], v[80:83], v[160:163]
  v_cvt_pk_bf16_f32 v71, v46, v47
  v_cvt_pk_bf16_f32 v72, v48, v49
  v_mfma_f32_16x16x32_bf16 v[176:179], a[184:187], v[84:87], v[176:179]
  buffer_load_dwordx4 v5, s[16:19], s68 offen offset:1024 lds
  v_mfma_f32_16x16x32_bf16 v[164:167], a[188:191], v[80:83], v[164:167]
  v_exp_f32_e64 v52, v52
  v_mfma_f32_16x16x32_bf16 v[180:183], a[188:191], v[84:87], v[180:183]
  v_exp_f32_e64 v53, v53
  v_mfma_f32_16x16x32_bf16 a[16:19], a[192:195], v[80:83], a[16:19]
  v_exp_f32_e64 v54, v54
  v_mfma_f32_16x16x32_bf16 a[32:35], a[192:195], v[84:87], a[32:35]
  v_exp_f32_e64 v55, v55
  v_mfma_f32_16x16x32_bf16 a[20:23], a[196:199], v[80:83], a[20:23]
  v_cvt_pk_bf16_f32 v73, v50, v51
  v_cvt_pk_bf16_f32 v74, v52, v53
  v_mfma_f32_16x16x32_bf16 a[36:39], a[196:199], v[84:87], a[36:39]
  buffer_load_dwordx4 v6, s[16:19], s68 offen offset:2048 lds
  v_mfma_f32_16x16x32_bf16 a[24:27], a[200:203], v[80:83], a[24:27]
  v_exp_f32_e64 v56, v56
  v_mfma_f32_16x16x32_bf16 a[40:43], a[200:203], v[84:87], a[40:43]
  s_waitcnt vmcnt(19)
  s_nop 0
  v_mfma_f32_16x16x32_bf16 a[28:31], a[204:207], v[80:83], a[28:31]
  ds_read_b64_tr_b16 a[176:177], v14 offset:16384
  ds_read_b64_tr_b16 a[178:179], v14 offset:20480
  v_mfma_f32_16x16x32_bf16 a[44:47], a[204:207], v[84:87], a[44:47]
  v_exp_f32_e64 v57, v57
  v_mfma_f32_16x16x32_bf16 v[116:119], v[28:31], v[80:83], v[116:119]
  ds_read_b64_tr_b16 a[180:181], v15 offset:16384
  ds_read_b64_tr_b16 a[182:183], v15 offset:20480
  v_mfma_f32_16x16x32_bf16 v[120:123], v[28:31], v[84:87], v[120:123]
  buffer_load_dwordx4 v7, s[16:19], s68 offen offset:3072 lds
  v_mfma_f32_16x16x32_bf16 v[32:35], a[144:147], v[200:203], v[92:95]
  ds_read_b64_tr_b16 a[184:185], v16 offset:16384
  ds_read_b64_tr_b16 a[186:187], v16 offset:20480
  v_mfma_f32_16x16x32_bf16 v[32:35], a[148:151], v[204:207], v[32:35]
  v_exp_f32_e64 v58, v58
  v_mfma_f32_16x16x32_bf16 v[32:35], a[152:155], v[208:211], v[32:35]
  ds_read_b64_tr_b16 a[188:189], v17 offset:16384
  ds_read_b64_tr_b16 a[190:191], v17 offset:20480
  v_mfma_f32_16x16x32_bf16 v[32:35], a[156:159], v[212:215], v[32:35]
  v_lshrrev_b32_e64 v239, 5, v0
  v_lshl_add_u32 v239, v239, 7, s33
  v_mfma_f32_16x16x32_bf16 v[36:39], a[160:163], v[200:203], v[92:95]
  ds_read_b64_tr_b16 a[192:193], v18 offset:16384
  ds_read_b64_tr_b16 a[194:195], v18 offset:20480
  v_mfma_f32_16x16x32_bf16 v[36:39], a[164:167], v[204:207], v[36:39]
  v_min_u32 v239, (L_codeend-L_pc-4), v239
  v_cvt_pk_bf16_f32 v75, v54, v55
  v_mfma_f32_16x16x32_bf16 v[36:39], a[168:171], v[208:211], v[36:39]
  ds_read_b64_tr_b16 a[196:197], v19 offset:16384
  ds_read_b64_tr_b16 a[198:199], v19 offset:20480
  v_mfma_f32_16x16x32_bf16 v[36:39], a[172:175], v[212:215], v[36:39]
  global_load_dword v239, v239, s[44:45]
  v_mfma_f32_16x16x32_bf16 v[40:43], a[144:147], v[216:219], v[96:99]
  ds_read_b64_tr_b16 a[200:201], v20 offset:16384
  ds_read_b64_tr_b16 a[202:203], v20 offset:20480
  v_mfma_f32_16x16x32_bf16 v[40:43], a[148:151], v[220:223], v[40:43]
  v_exp_f32_e64 v59, v59
  v_mfma_f32_16x16x32_bf16 v[40:43], a[152:155], v[224:227], v[40:43]
  ds_read_b64_tr_b16 a[204:205], v21 offset:16384
  ds_read_b64_tr_b16 a[206:207], v21 offset:20480
  v_mfma_f32_16x16x32_bf16 v[40:43], a[156:159], v[228:231], v[40:43]
  s_add_u32 m0, s35, 4096
  v_cvt_pk_bf16_f32 v76, v56, v57
  v_mfma_f32_16x16x32_bf16 v[44:47], a[160:163], v[216:219], v[96:99]
  buffer_load_dwordx4 v4, s[16:19], s76 offen offset:0 lds
  v_mfma_f32_16x16x32_bf16 v[44:47], a[164:167], v[220:223], v[44:47]
  s_waitcnt vmcnt(14)
  s_nop 0
  v_mfma_f32_16x16x32_bf16 v[44:47], a[168:171], v[224:227], v[44:47]
  ds_read_b128 a[144:147], v10 offset:8192
  ds_read_b128 a[148:151], v11 offset:8192
  v_mfma_f32_16x16x32_bf16 v[44:47], a[172:175], v[228:231], v[44:47]
  s_waitcnt lgkmcnt(10)
  s_nop 0
  v_mfma_f32_16x16x32_bf16 a[48:51], a[176:179], v[64:67], a[48:51]
  buffer_load_dwordx4 v5, s[16:19], s76 offen offset:1024 lds
  v_mfma_f32_16x16x32_bf16 a[64:67], a[176:179], v[68:71], a[64:67]
  buffer_load_dwordx4 v6, s[16:19], s76 offen offset:2048 lds
  v_mfma_f32_16x16x32_bf16 a[52:55], a[180:183], v[64:67], a[52:55]
  ds_read_b128 a[152:155], v12 offset:8192
  ds_read_b128 a[156:159], v13 offset:8192
  v_mfma_f32_16x16x32_bf16 a[68:71], a[180:183], v[68:71], a[68:71]
  v_exp_f32_e64 v60, v60
  v_mfma_f32_16x16x32_bf16 a[56:59], a[184:187], v[64:67], a[56:59]
  v_exp_f32_e64 v61, v61
  v_mfma_f32_16x16x32_bf16 a[72:75], a[184:187], v[68:71], a[72:75]
  s_waitcnt lgkmcnt(4)
  s_nop 0
  v_mfma_f32_16x16x32_bf16 a[60:63], a[188:191], v[64:67], a[60:63]
  ds_read_b128 a[160:163], v10 offset:12288
  ds_read_b128 a[164:167], v11 offset:12288
  v_mfma_f32_16x16x32_bf16 a[76:79], a[188:191], v[68:71], a[76:79]
  buffer_load_dwordx4 v7, s[16:19], s76 offen offset:3072 lds
  v_mfma_f32_16x16x32_bf16 a[96:99], a[192:195], v[64:67], a[96:99]
  v_exp_f32_e64 v62, v62
  v_mfma_f32_16x16x32_bf16 a[112:115], a[192:195], v[68:71], a[112:115]
  v_exp_f32_e64 v63, v63
  v_mfma_f32_16x16x32_bf16 a[100:103], a[196:199], v[64:67], a[100:103]
  ds_read_b128 a[168:171], v12 offset:12288
  ds_read_b128 a[172:175], v13 offset:12288
  v_mfma_f32_16x16x32_bf16 a[116:119], a[196:199], v[68:71], a[116:119]
  v_cvt_pk_bf16_f32 v77, v58, v59
  v_cvt_pk_bf16_f32 v78, v60, v61
  v_mfma_f32_16x16x32_bf16 a[104:107], a[200:203], v[64:67], a[104:107]
  v_exp_f32_e64 v32, v32
  v_mfma_f32_16x16x32_bf16 a[120:123], a[200:203], v[68:71], a[120:123]
  v_exp_f32_e64 v33, v33
  v_mfma_f32_16x16x32_bf16 a[108:111], a[204:207], v[64:67], a[108:111]
  v_exp_f32_e64 v34, v34
  v_mfma_f32_16x16x32_bf16 a[124:127], a[204:207], v[68:71], a[124:127]
  v_exp_f32_e64 v35, v35
  v_mfma_f32_16x16x32_bf16 v[124:127], v[28:31], v[64:67], v[124:127]
  v_cvt_pk_bf16_f32 v79, v62, v63
  v_cvt_pk_bf16_f32 v80, v32, v33
  v_mfma_f32_16x16x32_bf16 v[128:131], v[28:31], v[68:71], v[128:131]
  s_waitcnt lgkmcnt(0)
  s_nop 0
  v_mfma_f32_16x16x32_bf16 v[48:51], a[144:147], a[208:211], v[100:103]
  v_exp_f32_e64 v36, v36
  v_mfma_f32_16x16x32_bf16 v[48:51], a[148:151], a[212:215], v[48:51]
  v_exp_f32_e64 v37, v37
  v_mfma_f32_16x16x32_bf16 v[48:51], a[152:155], a[216:219], v[48:51]
  v_exp_f32_e64 v38, v38
  v_mfma_f32_16x16x32_bf16 v[48:51], a[156:159], a[220:223], v[48:51]
  v_exp_f32_e64 v39, v39
  v_mfma_f32_16x16x32_bf16 v[52:55], a[160:163], a[208:211], v[100:103]
  v_cvt_pk_bf16_f32 v81, v34, v35
  v_cvt_pk_bf16_f32 v82, v36, v37
  v_mfma_f32_16x16x32_bf16 v[52:55], a[164:167], a[212:215], v[52:55]
  s_add_u32 m0, s35, 16384
  v_cvt_pk_bf16_f32 v83, v38, v39
  v_mfma_f32_16x16x32_bf16 v[52:55], a[168:171], a[216:219], v[52:55]
  buffer_load_dwordx4 v8, s[20:23], s68 offen offset:0 lds
  v_mfma_f32_16x16x32_bf16 v[52:55], a[172:175], a[220:223], v[52:55]
  v_exp_f32_e64 v40, v40
  v_mfma_f32_16x16x32_bf16 v[56:59], a[144:147], a[224:227], v[104:107]
  v_exp_f32_e64 v41, v41
  v_mfma_f32_16x16x32_bf16 v[56:59], a[148:151], a[228:231], v[56:59]
  v_exp_f32_e64 v42, v42
  v_mfma_f32_16x16x32_bf16 v[56:59], a[152:155], a[232:235], v[56:59]
  v_exp_f32_e64 v43, v43
  v_mfma_f32_16x16x32_bf16 v[56:59], a[156:159], a[236:239], v[56:59]
  buffer_load_dwordx4 v9, s[20:23], s68 offen offset:1024 lds
  v_mfma_f32_16x16x32_bf16 v[60:63], a[160:163], a[224:227], v[104:107]
  v_exp_f32_e64 v44, v44
  v_mfma_f32_16x16x32_bf16 v[60:63], a[164:167], a[228:231], v[60:63]
  v_exp_f32_e64 v45, v45
  v_mfma_f32_16x16x32_bf16 v[60:63], a[168:171], a[232:235], v[60:63]
  v_cvt_pk_bf16_f32 v84, v40, v41
  v_cvt_pk_bf16_f32 v85, v42, v43
  v_mfma_f32_16x16x32_bf16 v[60:63], a[172:175], a[236:239], v[60:63]
  v_exp_f32_e64 v46, v46
  v_mfma_f32_16x16x32_bf16 a[80:83], a[176:179], v[72:75], a[80:83]
  v_exp_f32_e64 v47, v47
  v_mfma_f32_16x16x32_bf16 v[136:139], a[176:179], v[76:79], v[136:139]
  buffer_load_dwordx4 v1, s[20:23], s68 offen offset:2048 lds
  v_mfma_f32_16x16x32_bf16 a[84:87], a[180:183], v[72:75], a[84:87]
  v_exp_f32_e64 v48, v48
  v_mfma_f32_16x16x32_bf16 v[140:143], a[180:183], v[76:79], v[140:143]
  v_exp_f32_e64 v49, v49
  v_mfma_f32_16x16x32_bf16 a[88:91], a[184:187], v[72:75], a[88:91]
  v_cvt_pk_bf16_f32 v86, v44, v45
  v_cvt_pk_bf16_f32 v87, v46, v47
  v_mfma_f32_16x16x32_bf16 v[144:147], a[184:187], v[76:79], v[144:147]
  v_exp_f32_e64 v50, v50
  v_mfma_f32_16x16x32_bf16 a[92:95], a[188:191], v[72:75], a[92:95]
  v_exp_f32_e64 v51, v51
  v_mfma_f32_16x16x32_bf16 v[148:151], a[188:191], v[76:79], v[148:151]
  buffer_load_dwordx4 v2, s[20:23], s68 offen offset:3072 lds
  v_mfma_f32_16x16x32_bf16 a[128:131], a[192:195], v[72:75], a[128:131]
  v_exp_f32_e64 v52, v52
  v_mfma_f32_16x16x32_bf16 a[0:3], a[192:195], v[76:79], a[0:3]
  v_exp_f32_e64 v53, v53
  v_mfma_f32_16x16x32_bf16 a[132:135], a[196:199], v[72:75], a[132:135]
  v_cvt_pk_bf16_f32 v64, v48, v49
  v_cvt_pk_bf16_f32 v65, v50, v51
  v_mfma_f32_16x16x32_bf16 a[4:7], a[196:199], v[76:79], a[4:7]
  v_exp_f32_e64 v54, v54
  v_mfma_f32_16x16x32_bf16 a[136:139], a[200:203], v[72:75], a[136:139]
  s_add_u32 m0, s35, 20480
  v_cvt_pk_bf16_f32 v66, v52, v53
  v_mfma_f32_16x16x32_bf16 a[8:11], a[200:203], v[76:79], a[8:11]
  buffer_load_dwordx4 v8, s[20:23], s76 offen offset:0 lds
  v_mfma_f32_16x16x32_bf16 a[140:143], a[204:207], v[72:75], a[140:143]
  v_exp_f32_e64 v55, v55
  v_mfma_f32_16x16x32_bf16 a[12:15], a[204:207], v[76:79], a[12:15]
  v_exp_f32_e64 v56, v56
  v_mfma_f32_16x16x32_bf16 v[132:135], v[28:31], v[72:75], v[132:135]
  v_exp_f32_e64 v57, v57
  v_mfma_f32_16x16x32_bf16 v[112:115], v[28:31], v[76:79], v[112:115]
  v_exp_f32_e64 v58, v58
  v_mfma_f32_16x16x32_bf16 v[32:35], a[144:147], a[240:243], v[108:111]
  v_exp_f32_e64 v59, v59
  v_mfma_f32_16x16x32_bf16 v[32:35], a[148:151], a[244:247], v[32:35]
  buffer_load_dwordx4 v9, s[20:23], s76 offen offset:1024 lds
  v_mfma_f32_16x16x32_bf16 v[32:35], a[152:155], a[248:251], v[32:35]
  v_cvt_pk_bf16_f32 v67, v54, v55
  v_cvt_pk_bf16_f32 v68, v56, v57
  v_mfma_f32_16x16x32_bf16 v[32:35], a[156:159], a[252:255], v[32:35]
  v_exp_f32_e64 v60, v60
  v_mfma_f32_16x16x32_bf16 v[36:39], a[160:163], a[240:243], v[108:111]
  v_exp_f32_e64 v61, v61
  v_mfma_f32_16x16x32_bf16 v[36:39], a[164:167], a[244:247], v[36:39]
  v_exp_f32_e64 v62, v62
  v_mfma_f32_16x16x32_bf16 v[36:39], a[168:171], a[248:251], v[36:39]
  v_exp_f32_e64 v63, v63
  v_mfma_f32_16x16x32_bf16 v[36:39], a[172:175], a[252:255], v[36:39]
  buffer_load_dwordx4 v1, s[20:23], s76 offen offset:2048 lds
  v_mfma_f32_16x16x32_bf16 v[40:43], a[144:147], v[184:187], v[88:91]
  v_cvt_pk_bf16_f32 v69, v58, v59
  v_cvt_pk_bf16_f32 v70, v60, v61
  v_mfma_f32_16x16x32_bf16 v[40:43], a[148:151], v[188:191], v[40:43]
  v_exp_f32_e64 v32, v32
  v_mfma_f32_16x16x32_bf16 v[40:43], a[152:155], v[192:195], v[40:43]
  v_exp_f32_e64 v33, v33
  v_mfma_f32_16x16x32_bf16 v[40:43], a[156:159], v[196:199], v[40:43]
  v_exp_f32_e64 v34, v34
  v_mfma_f32_16x16x32_bf16 v[44:47], a[160:163], v[184:187], v[88:91]
  v_exp_f32_e64 v35, v35
  v_mfma_f32_16x16x32_bf16 v[44:47], a[164:167], v[188:191], v[44:47]
  buffer_load_dwordx4 v2, s[20:23], s76 offen offset:3072 lds
  v_mfma_f32_16x16x32_bf16 v[44:47], a[168:171], v[192:195], v[44:47]
  v_cvt_pk_bf16_f32 v71, v62, v63
  v_cvt_pk_bf16_f32 v72, v32, v33
  v_mfma_f32_16x16x32_bf16 v[44:47], a[172:175], v[196:199], v[44:47]
  s_add_u32 m0, s35, 8192
  v_cvt_pk_bf16_f32 v73, v34, v35
  v_mfma_f32_16x16x32_bf16 v[152:155], a[176:179], v[80:83], v[152:155]
  buffer_load_dwordx4 v4, s[16:19], s69 offen offset:0 lds
  v_mfma_f32_16x16x32_bf16 v[168:171], a[176:179], v[84:87], v[168:171]
  v_exp_f32_e64 v36, v36
  v_mfma_f32_16x16x32_bf16 v[156:159], a[180:183], v[80:83], v[156:159]
  v_exp_f32_e64 v37, v37
  v_mfma_f32_16x16x32_bf16 v[172:175], a[180:183], v[84:87], v[172:175]
  v_exp_f32_e64 v38, v38
  v_mfma_f32_16x16x32_bf16 v[160:163], a[184:187], v[80:83], v[160:163]
  v_exp_f32_e64 v39, v39
  v_mfma_f32_16x16x32_bf16 v[176:179], a[184:187], v[84:87], v[176:179]
  buffer_load_dwordx4 v5, s[16:19], s69 offen offset:1024 lds
  v_mfma_f32_16x16x32_bf16 v[164:167], a[188:191], v[80:83], v[164:167]
  v_exp_f32_e64 v40, v40
  v_mfma_f32_16x16x32_bf16 v[180:183], a[188:191], v[84:87], v[180:183]
  v_exp_f32_e64 v41, v41
  v_mfma_f32_16x16x32_bf16 a[16:19], a[192:195], v[80:83], a[16:19]
  v_cvt_pk_bf16_f32 v74, v36, v37
  v_cvt_pk_bf16_f32 v75, v38, v39
  v_mfma_f32_16x16x32_bf16 a[32:35], a[192:195], v[84:87], a[32:35]
  v_exp_f32_e64 v42, v42
  v_mfma_f32_16x16x32_bf16 a[20:23], a[196:199], v[80:83], a[20:23]
  v_exp_f32_e64 v43, v43
  v_mfma_f32_16x16x32_bf16 a[36:39], a[196:199], v[84:87], a[36:39]
  buffer_load_dwordx4 v6, s[16:19], s69 offen offset:2048 lds
  v_mfma_f32_16x16x32_bf16 a[24:27], a[200:203], v[80:83], a[24:27]
  v_exp_f32_e64 v44, v44
  v_mfma_f32_16x16x32_bf16 a[40:43], a[200:203], v[84:87], a[40:43]
  s_waitcnt vmcnt(20)
  s_nop 0
  v_mfma_f32_16x16x32_bf16 a[28:31], a[204:207], v[80:83], a[28:31]
  ds_read_b64_tr_b16 a[176:177], v14 offset:24576
  ds_read_b64_tr_b16 a[178:179], v14 offset:28672
  v_mfma_f32_16x16x32_bf16 a[44:47], a[204:207], v[84:87], a[44:47]
  v_exp_f32_e64 v45, v45
  v_mfma_f32_16x16x32_bf16 v[116:119], v[28:31], v[80:83], v[116:119]
  ds_read_b64_tr_b16 a[180:181], v15 offset:24576
  ds_read_b64_tr_b16 a[182:183], v15 offset:28672
  v_mfma_f32_16x16x32_bf16 v[120:123], v[28:31], v[84:87], v[120:123]
  buffer_load_dwordx4 v7, s[16:19], s69 offen offset:3072 lds
  v_mfma_f32_16x16x32_bf16 v[48:51], a[144:147], v[200:203], v[92:95]
  ds_read_b64_tr_b16 a[184:185], v16 offset:24576
  ds_read_b64_tr_b16 a[186:187], v16 offset:28672
  v_mfma_f32_16x16x32_bf16 v[48:51], a[148:151], v[204:207], v[48:51]
  v_cvt_pk_bf16_f32 v76, v40, v41
  v_cvt_pk_bf16_f32 v77, v42, v43
  v_mfma_f32_16x16x32_bf16 v[48:51], a[152:155], v[208:211], v[48:51]
  ds_read_b64_tr_b16 a[188:189], v17 offset:24576
  ds_read_b64_tr_b16 a[190:191], v17 offset:28672
  v_mfma_f32_16x16x32_bf16 v[48:51], a[156:159], v[212:215], v[48:51]
  v_exp_f32_e64 v46, v46
  v_mfma_f32_16x16x32_bf16 v[52:55], a[160:163], v[200:203], v[92:95]
  ds_read_b64_tr_b16 a[192:193], v18 offset:24576
  ds_read_b64_tr_b16 a[194:195], v18 offset:28672
  v_mfma_f32_16x16x32_bf16 v[52:55], a[164:167], v[204:207], v[52:55]
  v_exp_f32_e64 v47, v47
  v_mfma_f32_16x16x32_bf16 v[52:55], a[168:171], v[208:211], v[52:55]
  ds_read_b64_tr_b16 a[196:197], v19 offset:24576
  ds_read_b64_tr_b16 a[198:199], v19 offset:28672
  v_mfma_f32_16x16x32_bf16 v[52:55], a[172:175], v[212:215], v[52:55]
  v_exp_f32_e64 v48, v48
  v_mfma_f32_16x16x32_bf16 v[56:59], a[144:147], v[216:219], v[96:99]
  ds_read_b64_tr_b16 a[200:201], v20 offset:24576
  ds_read_b64_tr_b16 a[202:203], v20 offset:28672
  v_mfma_f32_16x16x32_bf16 v[56:59], a[148:151], v[220:223], v[56:59]
  v_exp_f32_e64 v49, v49
  v_mfma_f32_16x16x32_bf16 v[56:59], a[152:155], v[224:227], v[56:59]
  ds_read_b64_tr_b16 a[204:205], v21 offset:24576
  ds_read_b64_tr_b16 a[206:207], v21 offset:28672
  v_mfma_f32_16x16x32_bf16 v[56:59], a[156:159], v[228:231], v[56:59]
  s_add_u32 m0, s35, 12288
  v_cvt_pk_bf16_f32 v78, v44, v45
  v_mfma_f32_16x16x32_bf16 v[60:63], a[160:163], v[216:219], v[96:99]
  buffer_load_dwordx4 v4, s[16:19], s77 offen offset:0 lds
  v_mfma_f32_16x16x32_bf16 v[60:63], a[164:167], v[220:223], v[60:63]
  s_waitcnt vmcnt(13)
  s_nop 0
  v_mfma_f32_16x16x32_bf16 v[60:63], a[168:171], v[224:227], v[60:63]
  ds_read_b128 a[144:147], v10 offset:0
  ds_read_b128 a[148:151], v11 offset:0
  v_mfma_f32_16x16x32_bf16 v[60:63], a[172:175], v[228:231], v[60:63]
  s_waitcnt lgkmcnt(10)
  s_nop 0
  v_mfma_f32_16x16x32_bf16 a[48:51], a[176:179], v[64:67], a[48:51]
  buffer_load_dwordx4 v5, s[16:19], s77 offen offset:1024 lds
  v_mfma_f32_16x16x32_bf16 a[64:67], a[176:179], v[68:71], a[64:67]
  buffer_load_dwordx4 v6, s[16:19], s77 offen offset:2048 lds
  v_mfma_f32_16x16x32_bf16 a[52:55], a[180:183], v[64:67], a[52:55]
  ds_read_b128 a[152:155], v12 offset:0
  ds_read_b128 a[156:159], v13 offset:0
  v_mfma_f32_16x16x32_bf16 a[68:71], a[180:183], v[68:71], a[68:71]
  v_exp_f32_e64 v50, v50
  v_mfma_f32_16x16x32_bf16 a[56:59], a[184:187], v[64:67], a[56:59]
  v_exp_f32_e64 v51, v51
  v_mfma_f32_16x16x32_bf16 a[72:75], a[184:187], v[68:71], a[72:75]
  s_waitcnt lgkmcnt(4)
  s_nop 0
  v_mfma_f32_16x16x32_bf16 a[60:63], a[188:191], v[64:67], a[60:63]
  ds_read_b128 a[160:163], v10 offset:4096
  ds_read_b128 a[164:167], v11 offset:4096
  v_mfma_f32_16x16x32_bf16 a[76:79], a[188:191], v[68:71], a[76:79]
  buffer_load_dwordx4 v7, s[16:19], s77 offen offset:3072 lds
  v_mfma_f32_16x16x32_bf16 a[96:99], a[192:195], v[64:67], a[96:99]
  v_cvt_pk_bf16_f32 v79, v46, v47
  v_cvt_pk_bf16_f32 v80, v48, v49
  v_mfma_f32_16x16x32_bf16 a[112:115], a[192:195], v[68:71], a[112:115]
  v_exp_f32_e64 v52, v52
  v_mfma_f32_16x16x32_bf16 a[100:103], a[196:199], v[64:67], a[100:103]
  ds_read_b128 a[168:171], v12 offset:4096
  ds_read_b128 a[172:175], v13 offset:4096
  v_mfma_f32_16x16x32_bf16 a[116:119], a[196:199], v[68:71], a[116:119]
  v_exp_f32_e64 v53, v53
  v_mfma_f32_16x16x32_bf16 a[104:107], a[200:203], v[64:67], a[104:107]
  v_exp_f32_e64 v54, v54
  v_mfma_f32_16x16x32_bf16 a[120:123], a[200:203], v[68:71], a[120:123]
  v_exp_f32_e64 v55, v55
  v_mfma_f32_16x16x32_bf16 a[108:111], a[204:207], v[64:67], a[108:111]
  v_cvt_pk_bf16_f32 v81, v50, v51
  v_cvt_pk_bf16_f32 v82, v52, v53
  v_mfma_f32_16x16x32_bf16 a[124:127], a[204:207], v[68:71], a[124:127]
  v_exp_f32_e64 v56, v56
  v_mfma_f32_16x16x32_bf16 v[124:127], v[28:31], v[64:67], v[124:127]
  v_exp_f32_e64 v57, v57
  v_mfma_f32_16x16x32_bf16 v[128:131], v[28:31], v[68:71], v[128:131]
  s_waitcnt lgkmcnt(0)
  s_nop 0
  v_mfma_f32_16x16x32_bf16 v[32:35], a[144:147], a[208:211], v[100:103]
  v_exp_f32_e64 v58, v58
  v_mfma_f32_16x16x32_bf16 v[32:35], a[148:151], a[212:215], v[32:35]
  v_exp_f32_e64 v59, v59
  v_mfma_f32_16x16x32_bf16 v[32:35], a[152:155], a[216:219], v[32:35]
  v_cvt_pk_bf16_f32 v83, v54, v55
  v_cvt_pk_bf16_f32 v84, v56, v57
  v_mfma_f32_16x16x32_bf16 v[32:35], a[156:159], a[220:223], v[32:35]
  v_exp_f32_e64 v60, v60
  v_mfma_f32_16x16x32_bf16 v[36:39], a[160:163], a[208:211], v[100:103]
  v_exp_f32_e64 v61, v61
  v_mfma_f32_16x16x32_bf16 v[36:39], a[164:167], a[212:215], v[36:39]
  v_exp_f32_e64 v62, v62
  v_mfma_f32_16x16x32_bf16 v[36:39], a[168:171], a[216:219], v[36:39]
  v_exp_f32_e64 v63, v63
  v_mfma_f32_16x16x32_bf16 v[36:39], a[172:175], a[220:223], v[36:39]
  v_cvt_pk_bf16_f32 v85, v58, v59
  v_cvt_pk_bf16_f32 v86, v60, v61
  v_mfma_f32_16x16x32_bf16 v[40:43], a[144:147], a[224:227], v[104:107]
  v_exp_f32_e64 v32, v32
  v_mfma_f32_16x16x32_bf16 v[40:43], a[148:151], a[228:231], v[40:43]
  v_exp_f32_e64 v33, v33
  v_mfma_f32_16x16x32_bf16 v[40:43], a[152:155], a[232:235], v[40:43]
  v_exp_f32_e64 v34, v34
  v_mfma_f32_16x16x32_bf16 v[40:43], a[156:159], a[236:239], v[40:43]
  v_exp_f32_e64 v35, v35
  v_mfma_f32_16x16x32_bf16 v[44:47], a[160:163], a[224:227], v[104:107]
  s_add_u32 m0, s35, 24576
  v_cvt_pk_bf16_f32 v87, v62, v63
  v_mfma_f32_16x16x32_bf16 v[44:47], a[164:167], a[228:231], v[44:47]
  buffer_load_dwordx4 v8, s[20:23], s69 offen offset:0 lds
  v_mfma_f32_16x16x32_bf16 v[44:47], a[168:171], a[232:235], v[44:47]
  v_exp_f32_e64 v36, v36
  v_mfma_f32_16x16x32_bf16 v[44:47], a[172:175], a[236:239], v[44:47]
  v_exp_f32_e64 v37, v37
  v_mfma_f32_16x16x32_bf16 a[80:83], a[176:179], v[72:75], a[80:83]
  v_cvt_pk_bf16_f32 v64, v32, v33
  v_cvt_pk_bf16_f32 v65, v34, v35
  v_mfma_f32_16x16x32_bf16 v[136:139], a[176:179], v[76:79], v[136:139]
  v_exp_f32_e64 v38, v38
  v_mfma_f32_16x16x32_bf16 a[84:87], a[180:183], v[72:75], a[84:87]
  buffer_load_dwordx4 v9, s[20:23], s69 offen offset:1024 lds
  v_mfma_f32_16x16x32_bf16 v[140:143], a[180:183], v[76:79], v[140:143]
  v_exp_f32_e64 v39, v39
  v_mfma_f32_16x16x32_bf16 a[88:91], a[184:187], v[72:75], a[88:91]
  v_exp_f32_e64 v40, v40
  v_mfma_f32_16x16x32_bf16 v[144:147], a[184:187], v[76:79], v[144:147]
  v_exp_f32_e64 v41, v41
  v_mfma_f32_16x16x32_bf16 a[92:95], a[188:191], v[72:75], a[92:95]
  v_cvt_pk_bf16_f32 v66, v36, v37
  v_cvt_pk_bf16_f32 v67, v38, v39
  v_mfma_f32_16x16x32_bf16 v[148:151], a[188:191], v[76:79], v[148:151]
  v_exp_f32_e64 v42, v42
  v_mfma_f32_16x16x32_bf16 a[128:131], a[192:195], v[72:75], a[128:131]
  buffer_load_dwordx4 v1, s[20:23], s69 offen offset:2048 lds
  v_mfma_f32_16x16x32_bf16 a[0:3], a[192:195], v[76:79], a[0:3]
  v_exp_f32_e64 v43, v43
  v_mfma_f32_16x16x32_bf16 a[132:135], a[196:199], v[72:75], a[132:135]
  v_exp_f32_e64 v44, v44
  v_mfma_f32_16x16x32_bf16 a[4:7], a[196:199], v[76:79], a[4:7]
  v_exp_f32_e64 v45, v45
  v_mfma_f32_16x16x32_bf16 a[136:139], a[200:203], v[72:75], a[136:139]
  v_cvt_pk_bf16_f32 v68, v40, v41
  v_cvt_pk_bf16_f32 v69, v42, v43
  v_mfma_f32_16x16x32_bf16 a[8:11], a[200:203], v[76:79], a[8:11]
  v_exp_f32_e64 v46, v46
  v_mfma_f32_16x16x32_bf16 a[140:143], a[204:207], v[72:75], a[140:143]
  buffer_load_dwordx4 v2, s[20:23], s69 offen offset:3072 lds
  v_mfma_f32_16x16x32_bf16 a[12:15], a[204:207], v[76:79], a[12:15]
  v_exp_f32_e64 v47, v47
  v_mfma_f32_16x16x32_bf16 v[132:135], v[28:31], v[72:75], v[132:135]
  v_cvt_pk_bf16_f32 v70, v44, v45
  v_cvt_pk_bf16_f32 v71, v46, v47
  v_mfma_f32_16x16x32_bf16 v[112:115], v[28:31], v[76:79], v[112:115]
  v_mfma_f32_16x16x32_bf16 v[48:51], a[144:147], a[240:243], v[108:111]
  v_mfma_f32_16x16x32_bf16 v[48:51], a[148:151], a[244:247], v[48:51]
  s_add_u32 m0, s35, 28672
  v_mfma_f32_16x16x32_bf16 v[48:51], a[152:155], a[248:251], v[48:51]
  buffer_load_dwordx4 v8, s[20:23], s77 offen offset:0 lds
  v_mfma_f32_16x16x32_bf16 v[48:51], a[156:159], a[252:255], v[48:51]
  v_mfma_f32_16x16x32_bf16 v[52:55], a[160:163], a[240:243], v[108:111]
  v_mfma_f32_16x16x32_bf16 v[52:55], a[164:167], a[244:247], v[52:55]
  v_mfma_f32_16x16x32_bf16 v[52:55], a[168:171], a[248:251], v[52:55]
  v_exp_f32_e64 v48, v48
  v_mfma_f32_16x16x32_bf16 v[52:55], a[172:175], a[252:255], v[52:55]
  v_exp_f32_e64 v49, v49
  v_mfma_f32_16x16x32_bf16 v[56:59], a[144:147], v[184:187], v[88:91]
  buffer_load_dwordx4 v9, s[20:23], s77 offen offset:1024 lds
  v_mfma_f32_16x16x32_bf16 v[56:59], a[148:151], v[188:191], v[56:59]
  v_exp_f32_e64 v50, v50
  v_mfma_f32_16x16x32_bf16 v[56:59], a[152:155], v[192:195], v[56:59]
  v_exp_f32_e64 v51, v51
  v_mfma_f32_16x16x32_bf16 v[56:59], a[156:159], v[196:199], v[56:59]
  v_exp_f32_e64 v52, v52
  v_mfma_f32_16x16x32_bf16 v[60:63], a[160:163], v[184:187], v[88:91]
  v_exp_f32_e64 v53, v53
  v_mfma_f32_16x16x32_bf16 v[60:63], a[164:167], v[188:191], v[60:63]
  v_cvt_pk_bf16_f32 v72, v48, v49
  v_cvt_pk_bf16_f32 v73, v50, v51
  v_mfma_f32_16x16x32_bf16 v[60:63], a[168:171], v[192:195], v[60:63]
  buffer_load_dwordx4 v1, s[20:23], s77 offen offset:2048 lds
  v_mfma_f32_16x16x32_bf16 v[60:63], a[172:175], v[196:199], v[60:63]
  v_exp_f32_e64 v54, v54
  v_mfma_f32_16x16x32_bf16 v[152:155], a[176:179], v[80:83], v[152:155]
  v_exp_f32_e64 v55, v55
  v_mfma_f32_16x16x32_bf16 v[168:171], a[176:179], v[84:87], v[168:171]
  v_exp_f32_e64 v56, v56
  v_mfma_f32_16x16x32_bf16 v[156:159], a[180:183], v[80:83], v[156:159]
  v_exp_f32_e64 v57, v57
  v_mfma_f32_16x16x32_bf16 v[172:175], a[180:183], v[84:87], v[172:175]
  v_cvt_pk_bf16_f32 v74, v52, v53
  v_cvt_pk_bf16_f32 v75, v54, v55
  v_mfma_f32_16x16x32_bf16 v[160:163], a[184:187], v[80:83], v[160:163]
  buffer_load_dwordx4 v2, s[20:23], s77 offen offset:3072 lds
  v_mfma_f32_16x16x32_bf16 v[176:179], a[184:187], v[84:87], v[176:179]
  v_exp_f32_e64 v58, v58
  v_mfma_f32_16x16x32_bf16 v[164:167], a[188:191], v[80:83], v[164:167]
  s_add_u32 m0, s35, 0
  s_nop 0
  v_cvt_pk_bf16_f32 v76, v56, v57
  v_mfma_f32_16x16x32_bf16 v[180:183], a[188:191], v[84:87], v[180:183]
  buffer_load_dwordx4 v4, s[16:19], s70 offen offset:0 lds
  v_mfma_f32_16x16x32_bf16 a[16:19], a[192:195], v[80:83], a[16:19]
  v_exp_f32_e64 v59, v59
  v_mfma_f32_16x16x32_bf16 a[32:35], a[192:195], v[84:87], a[32:35]
  v_exp_f32_e64 v60, v60
  v_mfma_f32_16x16x32_bf16 a[20:23], a[196:199], v[80:83], a[20:23]
  v_exp_f32_e64 v61, v61
  v_mfma_f32_16x16x32_bf16 a[36:39], a[196:199], v[84:87], a[36:39]
  v_exp_f32_e64 v62, v62
  v_mfma_f32_16x16x32_bf16 a[24:27], a[200:203], v[80:83], a[24:27]
  buffer_load_dwordx4 v5, s[16:19], s70 offen offset:1024 lds
  v_mfma_f32_16x16x32_bf16 a[40:43], a[200:203], v[84:87], a[40:43]
  s_waitcnt vmcnt(18)
  s_nop 0
  v_mfma_f32_16x16x32_bf16 a[28:31], a[204:207], v[80:83], a[28:31]
  ds_read_b64_tr_b16 a[176:177], v14 offset:16384
  ds_read_b64_tr_b16 a[178:179], v14 offset:20480
  v_mfma_f32_16x16x32_bf16 a[44:47], a[204:207], v[84:87], a[44:47]
  v_exp_f32_e64 v63, v63
  v_mfma_f32_16x16x32_bf16 v[116:119], v[28:31], v[80:83], v[116:119]
  ds_read_b64_tr_b16 a[180:181], v15 offset:16384
  ds_read_b64_tr_b16 a[182:183], v15 offset:20480
  v_mfma_f32_16x16x32_bf16 v[120:123], v[28:31], v[84:87], v[120:123]
  v_cvt_pk_bf16_f32 v77, v58, v59
  v_cvt_pk_bf16_f32 v78, v60, v61
  v_mfma_f32_16x16x32_bf16 v[32:35], a[144:147], v[200:203], v[92:95]
  ds_read_b64_tr_b16 a[184:185], v16 offset:16384
  ds_read_b64_tr_b16 a[186:187], v16 offset:20480
  v_mfma_f32_16x16x32_bf16 v[32:35], a[148:151], v[204:207], v[32:35]
  buffer_load_dwordx4 v6, s[16:19], s70 offen offset:2048 lds
  v_mfma_f32_16x16x32_bf16 v[32:35], a[152:155], v[208:211], v[32:35]
  ds_read_b64_tr_b16 a[188:189], v17 offset:16384
  ds_read_b64_tr_b16 a[190:191], v17 offset:20480
  v_mfma_f32_16x16x32_bf16 v[32:35], a[156:159], v[212:215], v[32:35]
  v_cvt_pk_bf16_f32 v79, v62, v63
  v_mfma_f32_16x16x32_bf16 v[36:39], a[160:163], v[200:203], v[92:95]
  ds_read_b64_tr_b16 a[192:193], v18 offset:16384
  ds_read_b64_tr_b16 a[194:195], v18 offset:20480
  v_mfma_f32_16x16x32_bf16 v[36:39], a[164:167], v[204:207], v[36:39]
  v_mfma_f32_16x16x32_bf16 v[36:39], a[168:171], v[208:211], v[36:39]
  ds_read_b64_tr_b16 a[196:197], v19 offset:16384
  ds_read_b64_tr_b16 a[198:199], v19 offset:20480
  v_mfma_f32_16x16x32_bf16 v[36:39], a[172:175], v[212:215], v[36:39]
  buffer_load_dwordx4 v7, s[16:19], s70 offen offset:3072 lds
  v_mfma_f32_16x16x32_bf16 v[40:43], a[144:147], v[216:219], v[96:99]
  ds_read_b64_tr_b16 a[200:201], v20 offset:16384
  ds_read_b64_tr_b16 a[202:203], v20 offset:20480
  v_mfma_f32_16x16x32_bf16 v[40:43], a[148:151], v[220:223], v[40:43]
  v_exp_f32_e64 v32, v32
  v_mfma_f32_16x16x32_bf16 v[40:43], a[152:155], v[224:227], v[40:43]
  ds_read_b64_tr_b16 a[204:205], v21 offset:16384
  ds_read_b64_tr_b16 a[206:207], v21 offset:20480
  v_mfma_f32_16x16x32_bf16 v[40:43], a[156:159], v[228:231], v[40:43]
  s_add_u32 m0, s35, 4096
  v_mfma_f32_16x16x32_bf16 v[44:47], a[160:163], v[216:219], v[96:99]
  buffer_load_dwordx4 v4, s[16:19], s78 offen offset:0 lds
  v_mfma_f32_16x16x32_bf16 v[44:47], a[164:167], v[220:223], v[44:47]
  s_waitcnt vmcnt(13)
  s_nop 0
  v_mfma_f32_16x16x32_bf16 v[44:47], a[168:171], v[224:227], v[44:47]
  ds_read_b128 a[144:147], v10 offset:8192
  ds_read_b128 a[148:151], v11 offset:8192
  v_mfma_f32_16x16x32_bf16 v[44:47], a[172:175], v[228:231], v[44:47]
  s_waitcnt lgkmcnt(10)
  s_nop 0
  v_mfma_f32_16x16x32_bf16 a[48:51], a[176:179], v[64:67], a[48:51]
  v_exp_f32_e64 v33, v33
  v_mfma_f32_16x16x32_bf16 a[64:67], a[176:179], v[68:71], a[64:67]
  v_exp_f32_e64 v34, v34
  v_mfma_f32_16x16x32_bf16 a[52:55], a[180:183], v[64:67], a[52:55]
  ds_read_b128 a[152:155], v12 offset:8192
  ds_read_b128 a[156:159], v13 offset:8192
  v_mfma_f32_16x16x32_bf16 a[68:71], a[180:183], v[68:71], a[68:71]
  buffer_load_dwordx4 v5, s[16:19], s78 offen offset:1024 lds
  v_mfma_f32_16x16x32_bf16 a[56:59], a[184:187], v[64:67], a[56:59]
  v_exp_f32_e64 v35, v35
  v_mfma_f32_16x16x32_bf16 a[72:75], a[184:187], v[68:71], a[72:75]
  s_waitcnt lgkmcnt(4)
  s_nop 0
  v_mfma_f32_16x16x32_bf16 a[60:63], a[188:191], v[64:67], a[60:63]
  ds_read_b128 a[160:163], v10 offset:12288
  ds_read_b128 a[164:167], v11 offset:12288
  v_mfma_f32_16x16x32_bf16 a[76:79], a[188:191], v[68:71], a[76:79]
  v_exp_f32_e64 v36, v36
  v_mfma_f32_16x16x32_bf16 a[96:99], a[192:195], v[64:67], a[96:99]
  buffer_load_dwordx4 v6, s[16:19], s78 offen offset:2048 lds
  v_mfma_f32_16x16x32_bf16 a[112:115], a[192:195], v[68:71], a[112:115]
  v_exp_f32_e64 v37, v37
  v_mfma_f32_16x16x32_bf16 a[100:103], a[196:199], v[64:67], a[100:103]
  ds_read_b128 a[168:171], v12 offset:12288
  ds_read_b128 a[172:175], v13 offset:12288
  v_mfma_f32_16x16x32_bf16 a[116:119], a[196:199], v[68:71], a[116:119]
  v_cvt_pk_bf16_f32 v80, v32, v33
  v_cvt_pk_bf16_f32 v81, v34, v35
  v_mfma_f32_16x16x32_bf16 a[104:107], a[200:203], v[64:67], a[104:107]
  v_exp_f32_e64 v38, v38
  v_mfma_f32_16x16x32_bf16 a[120:123], a[200:203], v[68:71], a[120:123]
  v_exp_f32_e64 v39, v39
  v_mfma_f32_16x16x32_bf16 a[108:111], a[204:207], v[64:67], a[108:111]
  buffer_load_dwordx4 v7, s[16:19], s78 offen offset:3072 lds
  v_mfma_f32_16x16x32_bf16 a[124:127], a[204:207], v[68:71], a[124:127]
  v_exp_f32_e64 v40, v40
  v_mfma_f32_16x16x32_bf16 v[124:127], v[28:31], v[64:67], v[124:127]
  v_exp_f32_e64 v41, v41
  v_mfma_f32_16x16x32_bf16 v[128:131], v[28:31], v[68:71], v[128:131]
  s_waitcnt lgkmcnt(0)
  s_nop 0
  v_mfma_f32_16x16x32_bf16 v[48:51], a[144:147], a[208:211], v[100:103]
  v_cvt_pk_bf16_f32 v82, v36, v37
  v_cvt_pk_bf16_f32 v83, v38, v39
  v_mfma_f32_16x16x32_bf16 v[48:51], a[148:151], a[212:215], v[48:51]
  v_exp_f32_e64 v42, v42
  v_mfma_f32_16x16x32_bf16 v[48:51], a[152:155], a[216:219], v[48:51]
  v_exp_f32_e64 v43, v43
  v_mfma_f32_16x16x32_bf16 v[48:51], a[156:159], a[220:223], v[48:51]
  v_exp_f32_e64 v44, v44
  v_mfma_f32_16x16x32_bf16 v[52:55], a[160:163], a[208:211], v[100:103]
  v_exp_f32_e64 v45, v45
  v_mfma_f32_16x16x32_bf16 v[52:55], a[164:167], a[212:215], v[52:55]
  v_cvt_pk_bf16_f32 v84, v40, v41
  v_cvt_pk_bf16_f32 v85, v42, v43
  v_mfma_f32_16x16x32_bf16 v[52:55], a[168:171], a[216:219], v[52:55]
  v_exp_f32_e64 v46, v46
  v_mfma_f32_16x16x32_bf16 v[52:55], a[172:175], a[220:223], v[52:55]
  v_exp_f32_e64 v47, v47
  v_mfma_f32_16x16x32_bf16 v[56:59], a[144:147], a[224:227], v[104:107]
  v_exp_f32_e64 v48, v48
  v_mfma_f32_16x16x32_bf16 v[56:59], a[148:151], a[228:231], v[56:59]
  v_exp_f32_e64 v49, v49
  v_mfma_f32_16x16x32_bf16 v[56:59], a[152:155], a[232:235], v[56:59]
  v_cvt_pk_bf16_f32 v86, v44, v45
  v_cvt_pk_bf16_f32 v87, v46, v47
  v_mfma_f32_16x16x32_bf16 v[56:59], a[156:159], a[236:239], v[56:59]
  v_exp_f32_e64 v50, v50
  v_mfma_f32_16x16x32_bf16 v[60:63], a[160:163], a[224:227], v[104:107]
  v_exp_f32_e64 v51, v51
  v_mfma_f32_16x16x32_bf16 v[60:63], a[164:167], a[228:231], v[60:63]
  v_exp_f32_e64 v52, v52
  v_mfma_f32_16x16x32_bf16 v[60:63], a[168:171], a[232:235], v[60:63]
  v_exp_f32_e64 v53, v53
  v_mfma_f32_16x16x32_bf16 v[60:63], a[172:175], a[236:239], v[60:63]
  v_cvt_pk_bf16_f32 v64, v48, v49
  v_cvt_pk_bf16_f32 v65, v50, v51
  v_mfma_f32_16x16x32_bf16 a[80:83], a[176:179], v[72:75], a[80:83]
  v_exp_f32_e64 v54, v54
  v_mfma_f32_16x16x32_bf16 v[136:139], a[176:179], v[76:79], v[136:139]
  v_exp_f32_e64 v55, v55
  v_mfma_f32_16x16x32_bf16 a[84:87], a[180:183], v[72:75], a[84:87]
  v_exp_f32_e64 v56, v56
  v_mfma_f32_16x16x32_bf16 v[140:143], a[180:183], v[76:79], v[140:143]
  s_add_u32 m0, s35, 16384
  v_cvt_pk_bf16_f32 v66, v52, v53
  v_mfma_f32_16x16x32_bf16 a[88:91], a[184:187], v[72:75], a[88:91]
  buffer_load_dwordx4 v8, s[20:23], s70 offen offset:0 lds
  v_mfma_f32_16x16x32_bf16 v[144:147], a[184:187], v[76:79], v[144:147]
  v_exp_f32_e64 v57, v57
  v_mfma_f32_16x16x32_bf16 a[92:95], a[188:191], v[72:75], a[92:95]
  v_exp_f32_e64 v58, v58
  v_mfma_f32_16x16x32_bf16 v[148:151], a[188:191], v[76:79], v[148:151]
  v_exp_f32_e64 v59, v59
  v_mfma_f32_16x16x32_bf16 a[128:131], a[192:195], v[72:75], a[128:131]
  v_cvt_pk_bf16_f32 v67, v54, v55
  v_cvt_pk_bf16_f32 v68, v56, v57
  v_mfma_f32_16x16x32_bf16 a[0:3], a[192:195], v[76:79], a[0:3]
  buffer_load_dwordx4 v9, s[20:23], s70 offen offset:1024 lds
  v_mfma_f32_16x16x32_bf16 a[132:135], a[196:199], v[72:75], a[132:135]
  v_exp_f32_e64 v60, v60
  v_mfma_f32_16x16x32_bf16 a[4:7], a[196:199], v[76:79], a[4:7]
  v_exp_f32_e64 v61, v61
  v_mfma_f32_16x16x32_bf16 a[136:139], a[200:203], v[72:75], a[136:139]
  v_exp_f32_e64 v62, v62
  v_mfma_f32_16x16x32_bf16 a[8:11], a[200:203], v[76:79], a[8:11]
  v_exp_f32_e64 v63, v63
  v_mfma_f32_16x16x32_bf16 a[140:143], a[204:207], v[72:75], a[140:143]
  v_cvt_pk_bf16_f32 v69, v58, v59
  v_cvt_pk_bf16_f32 v70, v60, v61
  v_mfma_f32_16x16x32_bf16 a[12:15], a[204:207], v[76:79], a[12:15]
  buffer_load_dwordx4 v1, s[20:23], s70 offen offset:2048 lds
  v_mfma_f32_16x16x32_bf16 v[132:135], v[28:31], v[72:75], v[132:135]
  v_cvt_pk_bf16_f32 v71, v62, v63
  v_mfma_f32_16x16x32_bf16 v[112:115], v[28:31], v[76:79], v[112:115]
  v_mfma_f32_16x16x32_bf16 v[32:35], a[144:147], a[240:243], v[108:111]
  v_mfma_f32_16x16x32_bf16 v[32:35], a[148:151], a[244:247], v[32:35]
  v_mfma_f32_16x16x32_bf16 v[32:35], a[152:155], a[248:251], v[32:35]
  v_lshrrev_b32_e64 v239, 5, v0
  v_lshl_add_u32 v239, v239, 7, s33
  v_mfma_f32_16x16x32_bf16 v[32:35], a[156:159], a[252:255], v[32:35]
  buffer_load_dwordx4 v2, s[20:23], s70 offen offset:3072 lds
  v_mfma_f32_16x16x32_bf16 v[36:39], a[160:163], a[240:243], v[108:111]
  v_min_u32 v239, (L_codeend-L_pc-4), v239
  v_mfma_f32_16x16x32_bf16 v[36:39], a[164:167], a[244:247], v[36:39]
  global_load_dword v239, v239, s[44:45]
  v_mfma_f32_16x16x32_bf16 v[36:39], a[168:171], a[248:251], v[36:39]
  v_exp_f32_e64 v32, v32
  v_mfma_f32_16x16x32_bf16 v[36:39], a[172:175], a[252:255], v[36:39]
  v_exp_f32_e64 v33, v33
  v_mfma_f32_16x16x32_bf16 v[40:43], a[144:147], v[184:187], v[88:91]
  s_add_u32 m0, s35, 20480
  v_cvt_pk_bf16_f32 v72, v32, v33
  v_mfma_f32_16x16x32_bf16 v[40:43], a[148:151], v[188:191], v[40:43]
  buffer_load_dwordx4 v8, s[20:23], s78 offen offset:0 lds
  v_mfma_f32_16x16x32_bf16 v[40:43], a[152:155], v[192:195], v[40:43]
  v_exp_f32_e64 v34, v34
  v_mfma_f32_16x16x32_bf16 v[40:43], a[156:159], v[196:199], v[40:43]
  v_exp_f32_e64 v35, v35
  v_mfma_f32_16x16x32_bf16 v[44:47], a[160:163], v[184:187], v[88:91]
  v_exp_f32_e64 v36, v36
  v_mfma_f32_16x16x32_bf16 v[44:47], a[164:167], v[188:191], v[44:47]
  v_exp_f32_e64 v37, v37
  v_mfma_f32_16x16x32_bf16 v[44:47], a[168:171], v[192:195], v[44:47]
  v_exp_f32_e64 v38, v38
  v_mfma_f32_16x16x32_bf16 v[44:47], a[172:175], v[196:199], v[44:47]
  buffer_load_dwordx4 v9, s[20:23], s78 offen offset:1024 lds
  v_mfma_f32_16x16x32_bf16 v[152:155], a[176:179], v[80:83], v[152:155]
  v_exp_f32_e64 v39, v39
  v_mfma_f32_16x16x32_bf16 v[168:171], a[176:179], v[84:87], v[168:171]
  v_cvt_pk_bf16_f32 v73, v34, v35
  v_cvt_pk_bf16_f32 v74, v36, v37
  v_mfma_f32_16x16x32_bf16 v[156:159], a[180:183], v[80:83], v[156:159]
  v_exp_f32_e64 v40, v40
  v_mfma_f32_16x16x32_bf16 v[172:175], a[180:183], v[84:87], v[172:175]
  v_exp_f32_e64 v41, v41
  v_mfma_f32_16x16x32_bf16 v[160:163], a[184:187], v[80:83], v[160:163]
  v_exp_f32_e64 v42, v42
  v_mfma_f32_16x16x32_bf16 v[176:179], a[184:187], v[84:87], v[176:179]
  buffer_load_dwordx4 v1, s[20:23], s78 offen offset:2048 lds
  v_mfma_f32_16x16x32_bf16 v[164:167], a[188:191], v[80:83], v[164:167]
  v_exp_f32_e64 v43, v43
  v_mfma_f32_16x16x32_bf16 v[180:183], a[188:191], v[84:87], v[180:183]
  v_cvt_pk_bf16_f32 v75, v38, v39
  v_cvt_pk_bf16_f32 v76, v40, v41
  v_mfma_f32_16x16x32_bf16 a[16:19], a[192:195], v[80:83], a[16:19]
  v_exp_f32_e64 v44, v44
  v_mfma_f32_16x16x32_bf16 a[32:35], a[192:195], v[84:87], a[32:35]
  v_exp_f32_e64 v45, v45
  v_mfma_f32_16x16x32_bf16 a[20:23], a[196:199], v[80:83], a[20:23]
  v_exp_f32_e64 v46, v46
  v_mfma_f32_16x16x32_bf16 a[36:39], a[196:199], v[84:87], a[36:39]
  buffer_load_dwordx4 v2, s[20:23], s78 offen offset:3072 lds
  v_mfma_f32_16x16x32_bf16 a[24:27], a[200:203], v[80:83], a[24:27]
  v_exp_f32_e64 v47, v47
  v_mfma_f32_16x16x32_bf16 a[40:43], a[200:203], v[84:87], a[40:43]
  s_waitcnt vmcnt(17)
  s_nop 0
  v_mfma_f32_16x16x32_bf16 a[28:31], a[204:207], v[80:83], a[28:31]
  ds_read_b64_tr_b16 a[176:177], v14 offset:24576
  ds_read_b64_tr_b16 a[178:179], v14 offset:28672
  v_mfma_f32_16x16x32_bf16 a[44:47], a[204:207], v[84:87], a[44:47]
  v_cvt_pk_bf16_f32 v77, v42, v43
  v_cvt_pk_bf16_f32 v78, v44, v45
  v_mfma_f32_16x16x32_bf16 v[116:119], v[28:31], v[80:83], v[116:119]
  ds_read_b64_tr_b16 a[180:181], v15 offset:24576
  ds_read_b64_tr_b16 a[182:183], v15 offset:28672
  v_mfma_f32_16x16x32_bf16 v[120:123], v[28:31], v[84:87], v[120:123]
  v_cvt_pk_bf16_f32 v79, v46, v47
  v_mfma_f32_16x16x32_bf16 v[48:51], a[144:147], v[200:203], v[92:95]
  ds_read_b64_tr_b16 a[184:185], v16 offset:24576
  ds_read_b64_tr_b16 a[186:187], v16 offset:28672
  v_mfma_f32_16x16x32_bf16 v[48:51], a[148:151], v[204:207], v[48:51]
  v_mfma_f32_16x16x32_bf16 v[48:51], a[152:155], v[208:211], v[48:51]
  ds_read_b64_tr_b16 a[188:189], v17 offset:24576
  ds_read_b64_tr_b16 a[190:191], v17 offset:28672
  v_mfma_f32_16x16x32_bf16 v[48:51], a[156:159], v[212:215], v[48:51]
  v_mfma_f32_16x16x32_bf16 v[52:55], a[160:163], v[200:203], v[92:95]
  ds_read_b64_tr_b16 a[192:193], v18 offset:24576
  ds_read_b64_tr_b16 a[194:195], v18 offset:28672
  v_mfma_f32_16x16x32_bf16 v[52:55], a[164:167], v[204:207], v[52:55]
  v_mfma_f32_16x16x32_bf16 v[52:55], a[168:171], v[208:211], v[52:55]
  ds_read_b64_tr_b16 a[196:197], v19 offset:24576
  ds_read_b64_tr_b16 a[198:199], v19 offset:28672
  v_mfma_f32_16x16x32_bf16 v[52:55], a[172:175], v[212:215], v[52:55]
  v_exp_f32_e64 v48, v48
  v_mfma_f32_16x16x32_bf16 v[56:59], a[144:147], v[216:219], v[96:99]
  ds_read_b64_tr_b16 a[200:201], v20 offset:24576
  ds_read_b64_tr_b16 a[202:203], v20 offset:28672
  v_mfma_f32_16x16x32_bf16 v[56:59], a[148:151], v[220:223], v[56:59]
  v_exp_f32_e64 v49, v49
  v_mfma_f32_16x16x32_bf16 v[56:59], a[152:155], v[224:227], v[56:59]
  ds_read_b64_tr_b16 a[204:205], v21 offset:24576
  ds_read_b64_tr_b16 a[206:207], v21 offset:28672
  v_mfma_f32_16x16x32_bf16 v[56:59], a[156:159], v[228:231], v[56:59]
  s_add_u32 m0, s35, 8192
  v_cvt_pk_bf16_f32 v80, v48, v49
  v_mfma_f32_16x16x32_bf16 v[60:63], a[160:163], v[216:219], v[96:99]
  buffer_load_dwordx4 v4, s[16:19], s71 offen offset:0 lds
  v_mfma_f32_16x16x32_bf16 v[60:63], a[164:167], v[220:223], v[60:63]
  s_waitcnt vmcnt(10)
  s_nop 0
  v_mfma_f32_16x16x32_bf16 v[60:63], a[168:171], v[224:227], v[60:63]
  ds_read_b128 a[144:147], v10 offset:0
  ds_read_b128 a[148:151], v11 offset:0
  v_mfma_f32_16x16x32_bf16 v[60:63], a[172:175], v[228:231], v[60:63]
  s_waitcnt lgkmcnt(10)
  s_nop 0
  v_mfma_f32_16x16x32_bf16 a[48:51], a[176:179], v[64:67], a[48:51]
  buffer_load_dwordx4 v5, s[16:19], s71 offen offset:1024 lds
  v_mfma_f32_16x16x32_bf16 a[64:67], a[176:179], v[68:71], a[64:67]
  buffer_load_dwordx4 v6, s[16:19], s71 offen offset:2048 lds
  v_mfma_f32_16x16x32_bf16 a[52:55], a[180:183], v[64:67], a[52:55]
  ds_read_b128 a[152:155], v12 offset:0
  ds_read_b128 a[156:159], v13 offset:0
  v_mfma_f32_16x16x32_bf16 a[68:71], a[180:183], v[68:71], a[68:71]
  buffer_load_dwordx4 v7, s[16:19], s71 offen offset:3072 lds
  v_mfma_f32_16x16x32_bf16 a[56:59], a[184:187], v[64:67], a[56:59]
  v_exp_f32_e64 v50, v50
  v_mfma_f32_16x16x32_bf16 a[72:75], a[184:187], v[68:71], a[72:75]
  s_waitcnt lgkmcnt(4)
  s_nop 0
  v_mfma_f32_16x16x32_bf16 a[60:63], a[188:191], v[64:67], a[60:63]
  ds_read_b128 a[160:163], v10 offset:4096
  ds_read_b128 a[164:167], v11 offset:4096
  v_mfma_f32_16x16x32_bf16 a[76:79], a[188:191], v[68:71], a[76:79]
  s_add_u32 m0, s35, 12288
  v_mfma_f32_16x16x32_bf16 a[96:99], a[192:195], v[64:67], a[96:99]
  buffer_load_dwordx4 v4, s[16:19], s79 offen offset:0 lds
  v_mfma_f32_16x16x32_bf16 a[112:115], a[192:195], v[68:71], a[112:115]
  buffer_load_dwordx4 v5, s[16:19], s79 offen offset:1024 lds
  v_mfma_f32_16x16x32_bf16 a[100:103], a[196:199], v[64:67], a[100:103]
  ds_read_b128 a[168:171], v12 offset:4096
  ds_read_b128 a[172:175], v13 offset:4096
  v_mfma_f32_16x16x32_bf16 a[116:119], a[196:199], v[68:71], a[116:119]
  v_exp_f32_e64 v51, v51
  v_mfma_f32_16x16x32_bf16 a[104:107], a[200:203], v[64:67], a[104:107]
  v_exp_f32_e64 v52, v52
  v_mfma_f32_16x16x32_bf16 a[120:123], a[200:203], v[68:71], a[120:123]
  v_exp_f32_e64 v53, v53
  v_mfma_f32_16x16x32_bf16 a[108:111], a[204:207], v[64:67], a[108:111]
  v_exp_f32_e64 v54, v54
  v_mfma_f32_16x16x32_bf16 a[124:127], a[204:207], v[68:71], a[124:127]
  buffer_load_dwordx4 v6, s[16:19], s79 offen offset:2048 lds
  v_mfma_f32_16x16x32_bf16 v[124:127], v[28:31], v[64:67], v[124:127]
  v_exp_f32_e64 v55, v55
  v_mfma_f32_16x16x32_bf16 v[128:131], v[28:31], v[68:71], v[128:131]
  s_waitcnt lgkmcnt(0)
  s_nop 0
  v_mfma_f32_16x16x32_bf16 v[32:35], a[144:147], a[208:211], v[100:103]
  v_cvt_pk_bf16_f32 v81, v50, v51
  v_cvt_pk_bf16_f32 v82, v52, v53
  v_mfma_f32_16x16x32_bf16 v[32:35], a[148:151], a[212:215], v[32:35]
  v_exp_f32_e64 v56, v56
  v_mfma_f32_16x16x32_bf16 v[32:35], a[152:155], a[216:219], v[32:35]
  v_exp_f32_e64 v57, v57
  v_mfma_f32_16x16x32_bf16 v[32:35], a[156:159], a[220:223], v[32:35]
  buffer_load_dwordx4 v7, s[16:19], s79 offen offset:3072 lds
  v_mfma_f32_16x16x32_bf16 v[36:39], a[160:163], a[208:211], v[100:103]
  v_exp_f32_e64 v58, v58
  v_mfma_f32_16x16x32_bf16 v[36:39], a[164:167], a[212:215], v[36:39]
  v_exp_f32_e64 v59, v59
  v_mfma_f32_16x16x32_bf16 v[36:39], a[168:171], a[216:219], v[36:39]
  v_cvt_pk_bf16_f32 v83, v54, v55
  v_cvt_pk_bf16_f32 v84, v56, v57
  v_mfma_f32_16x16x32_bf16 v[36:39], a[172:175], a[220:223], v[36:39]
  v_exp_f32_e64 v60, v60
  v_mfma_f32_16x16x32_bf16 v[40:43], a[144:147], a[224:227], v[104:107]
  v_exp_f32_e64 v61, v61
  v_mfma_f32_16x16x32_bf16 v[40:43], a[148:151], a[228:231], v[40:43]
  v_exp_f32_e64 v62, v62
  v_mfma_f32_16x16x32_bf16 v[40:43], a[152:155], a[232:235], v[40:43]
  v_exp_f32_e64 v63, v63
  v_mfma_f32_16x16x32_bf16 v[40:43], a[156:159], a[236:239], v[40:43]
  v_cvt_pk_bf16_f32 v85, v58, v59
  v_cvt_pk_bf16_f32 v86, v60, v61
  v_mfma_f32_16x16x32_bf16 v[44:47], a[160:163], a[224:227], v[104:107]
  v_exp_f32_e64 v32, v32
  v_mfma_f32_16x16x32_bf16 v[44:47], a[164:167], a[228:231], v[44:47]
  v_exp_f32_e64 v33, v33
  v_mfma_f32_16x16x32_bf16 v[44:47], a[168:171], a[232:235], v[44:47]
  v_exp_f32_e64 v34, v34
  v_mfma_f32_16x16x32_bf16 v[44:47], a[172:175], a[236:239], v[44:47]
  v_exp_f32_e64 v35, v35
  v_mfma_f32_16x16x32_bf16 a[80:83], a[176:179], v[72:75], a[80:83]
  v_cvt_pk_bf16_f32 v87, v62, v63
  v_cvt_pk_bf16_f32 v64, v32, v33
  v_mfma_f32_16x16x32_bf16 v[136:139], a[176:179], v[76:79], v[136:139]
  v_exp_f32_e64 v36, v36
  v_mfma_f32_16x16x32_bf16 a[84:87], a[180:183], v[72:75], a[84:87]
  v_exp_f32_e64 v37, v37
  v_mfma_f32_16x16x32_bf16 v[140:143], a[180:183], v[76:79], v[140:143]
  v_exp_f32_e64 v38, v38
  v_mfma_f32_16x16x32_bf16 a[88:91], a[184:187], v[72:75], a[88:91]
  v_exp_f32_e64 v39, v39
  v_mfma_f32_16x16x32_bf16 v[144:147], a[184:187], v[76:79], v[144:147]
  v_cvt_pk_bf16_f32 v65, v34, v35
  v_cvt_pk_bf16_f32 v66, v36, v37
  v_mfma_f32_16x16x32_bf16 a[92:95], a[188:191], v[72:75], a[92:95]
  v_exp_f32_e64 v40, v40
  v_mfma_f32_16x16x32_bf16 v[148:151], a[188:191], v[76:79], v[148:151]
  v_exp_f32_e64 v41, v41
  v_mfma_f32_16x16x32_bf16 a[128:131], a[192:195], v[72:75], a[128:131]
  v_exp_f32_e64 v42, v42
  v_mfma_f32_16x16x32_bf16 a[0:3], a[192:195], v[76:79], a[0:3]
  v_exp_f32_e64 v43, v43
  v_mfma_f32_16x16x32_bf16 a[132:135], a[196:199], v[72:75], a[132:135]
  s_add_u32 m0, s35, 24576
  v_cvt_pk_bf16_f32 v67, v38, v39
  v_mfma_f32_16x16x32_bf16 a[4:7], a[196:199], v[76:79], a[4:7]
  buffer_load_dwordx4 v8, s[20:23], s71 offen offset:0 lds
  v_mfma_f32_16x16x32_bf16 a[136:139], a[200:203], v[72:75], a[136:139]
  v_exp_f32_e64 v44, v44
  v_mfma_f32_16x16x32_bf16 a[8:11], a[200:203], v[76:79], a[8:11]
  v_exp_f32_e64 v45, v45
  v_mfma_f32_16x16x32_bf16 a[140:143], a[204:207], v[72:75], a[140:143]
  buffer_load_dwordx4 v9, s[20:23], s71 offen offset:1024 lds
  v_mfma_f32_16x16x32_bf16 a[12:15], a[204:207], v[76:79], a[12:15]
  v_cvt_pk_bf16_f32 v68, v40, v41
  v_cvt_pk_bf16_f32 v69, v42, v43
  v_mfma_f32_16x16x32_bf16 v[132:135], v[28:31], v[72:75], v[132:135]
  v_exp_f32_e64 v46, v46
  v_mfma_f32_16x16x32_bf16 v[112:115], v[28:31], v[76:79], v[112:115]
  v_exp_f32_e64 v47, v47
  v_mfma_f32_16x16x32_bf16 v[48:51], a[144:147], a[240:243], v[108:111]
  v_cvt_pk_bf16_f32 v70, v44, v45
  v_cvt_pk_bf16_f32 v71, v46, v47
  v_mfma_f32_16x16x32_bf16 v[48:51], a[148:151], a[244:247], v[48:51]
  buffer_load_dwordx4 v1, s[20:23], s71 offen offset:2048 lds
  v_mfma_f32_16x16x32_bf16 v[48:51], a[152:155], a[248:251], v[48:51]
  v_mfma_f32_16x16x32_bf16 v[48:51], a[156:159], a[252:255], v[48:51]
  v_mfma_f32_16x16x32_bf16 v[52:55], a[160:163], a[240:243], v[108:111]
  v_mfma_f32_16x16x32_bf16 v[52:55], a[164:167], a[244:247], v[52:55]
  buffer_load_dwordx4 v2, s[20:23], s71 offen offset:3072 lds
  v_mfma_f32_16x16x32_bf16 v[52:55], a[168:171], a[248:251], v[52:55]
  v_exp_f32_e64 v48, v48
  v_mfma_f32_16x16x32_bf16 v[52:55], a[172:175], a[252:255], v[52:55]
  v_exp_f32_e64 v49, v49
  v_mfma_f32_16x16x32_bf16 v[56:59], a[144:147], v[184:187], v[88:91]
  v_exp_f32_e64 v50, v50
  v_mfma_f32_16x16x32_bf16 v[56:59], a[148:151], v[188:191], v[56:59]
  s_add_u32 m0, s35, 28672
  v_cvt_pk_bf16_f32 v72, v48, v49
  v_mfma_f32_16x16x32_bf16 v[56:59], a[152:155], v[192:195], v[56:59]
  buffer_load_dwordx4 v8, s[20:23], s79 offen offset:0 lds
  v_mfma_f32_16x16x32_bf16 v[56:59], a[156:159], v[196:199], v[56:59]
  v_exp_f32_e64 v51, v51
  v_mfma_f32_16x16x32_bf16 v[60:63], a[160:163], v[184:187], v[88:91]
  v_exp_f32_e64 v52, v52
  v_mfma_f32_16x16x32_bf16 v[60:63], a[164:167], v[188:191], v[60:63]
  v_exp_f32_e64 v53, v53
  v_mfma_f32_16x16x32_bf16 v[60:63], a[168:171], v[192:195], v[60:63]
  buffer_load_dwordx4 v9, s[20:23], s79 offen offset:1024 lds
  v_mfma_f32_16x16x32_bf16 v[60:63], a[172:175], v[196:199], v[60:63]
  v_exp_f32_e64 v54, v54
  v_mfma_f32_16x16x32_bf16 v[32:35], a[144:147], v[200:203], v[92:95]
  v_exp_f32_e64 v55, v55
  v_mfma_f32_16x16x32_bf16 v[32:35], a[148:151], v[204:207], v[32:35]
  v_cvt_pk_bf16_f32 v73, v50, v51
  v_cvt_pk_bf16_f32 v74, v52, v53
  v_mfma_f32_16x16x32_bf16 v[32:35], a[152:155], v[208:211], v[32:35]
  v_exp_f32_e64 v56, v56
  v_mfma_f32_16x16x32_bf16 v[32:35], a[156:159], v[212:215], v[32:35]
  buffer_load_dwordx4 v1, s[20:23], s79 offen offset:2048 lds
  v_mfma_f32_16x16x32_bf16 v[36:39], a[160:163], v[200:203], v[92:95]
  v_exp_f32_e64 v57, v57
  v_mfma_f32_16x16x32_bf16 v[36:39], a[164:167], v[204:207], v[36:39]
  v_exp_f32_e64 v58, v58
  v_mfma_f32_16x16x32_bf16 v[36:39], a[168:171], v[208:211], v[36:39]
  v_exp_f32_e64 v59, v59
  v_mfma_f32_16x16x32_bf16 v[36:39], a[172:175], v[212:215], v[36:39]
  buffer_load_dwordx4 v2, s[20:23], s79 offen offset:3072 lds
  v_mfma_f32_16x16x32_bf16 v[40:43], a[144:147], v[216:219], v[96:99]
  v_cvt_pk_bf16_f32 v75, v54, v55
  v_cvt_pk_bf16_f32 v76, v56, v57
  v_mfma_f32_16x16x32_bf16 v[40:43], a[148:151], v[220:223], v[40:43]
  v_exp_f32_e64 v60, v60
  v_mfma_f32_16x16x32_bf16 v[40:43], a[152:155], v[224:227], v[40:43]
  v_exp_f32_e64 v61, v61
  v_mfma_f32_16x16x32_bf16 v[40:43], a[156:159], v[228:231], v[40:43]
  v_exp_f32_e64 v62, v62
  v_mfma_f32_16x16x32_bf16 v[44:47], a[160:163], v[216:219], v[96:99]
  v_exp_f32_e64 v63, v63
  v_mfma_f32_16x16x32_bf16 v[44:47], a[164:167], v[220:223], v[44:47]
  s_waitcnt vmcnt(8)
  s_nop 0
  v_mfma_f32_16x16x32_bf16 v[44:47], a[168:171], v[224:227], v[44:47]
  ds_read_b128 a[144:147], v10 offset:8192
  ds_read_b128 a[148:151], v11 offset:8192
  v_mfma_f32_16x16x32_bf16 v[44:47], a[172:175], v[228:231], v[44:47]
  v_cvt_pk_bf16_f32 v77, v58, v59
  v_cvt_pk_bf16_f32 v78, v60, v61
  v_mfma_f32_16x16x32_bf16 v[152:155], a[176:179], v[80:83], v[152:155]
  v_exp_f32_e64 v32, v32
  v_mfma_f32_16x16x32_bf16 v[168:171], a[176:179], v[84:87], v[168:171]
  v_exp_f32_e64 v33, v33
  v_mfma_f32_16x16x32_bf16 v[156:159], a[180:183], v[80:83], v[156:159]
  ds_read_b128 a[152:155], v12 offset:8192
  ds_read_b128 a[156:159], v13 offset:8192
  v_mfma_f32_16x16x32_bf16 v[172:175], a[180:183], v[84:87], v[172:175]
  v_exp_f32_e64 v34, v34
  v_mfma_f32_16x16x32_bf16 v[160:163], a[184:187], v[80:83], v[160:163]
  v_exp_f32_e64 v35, v35
  v_mfma_f32_16x16x32_bf16 v[176:179], a[184:187], v[84:87], v[176:179]
  v_cvt_pk_bf16_f32 v79, v62, v63
  v_cvt_pk_bf16_f32 v232, v32, v33
  v_mfma_f32_16x16x32_bf16 v[164:167], a[188:191], v[80:83], v[164:167]
  ds_read_b128 a[160:163], v10 offset:12288
  ds_read_b128 a[164:167], v11 offset:12288
  v_mfma_f32_16x16x32_bf16 v[180:183], a[188:191], v[84:87], v[180:183]
  v_exp_f32_e64 v36, v36
  v_mfma_f32_16x16x32_bf16 a[16:19], a[192:195], v[80:83], a[16:19]
  v_exp_f32_e64 v37, v37
  v_mfma_f32_16x16x32_bf16 a[32:35], a[192:195], v[84:87], a[32:35]
  v_exp_f32_e64 v38, v38
  v_mfma_f32_16x16x32_bf16 a[20:23], a[196:199], v[80:83], a[20:23]
  ds_read_b128 a[168:171], v12 offset:12288
  ds_read_b128 a[172:175], v13 offset:12288
  v_mfma_f32_16x16x32_bf16 a[36:39], a[196:199], v[84:87], a[36:39]
  v_exp_f32_e64 v39, v39
  v_mfma_f32_16x16x32_bf16 a[24:27], a[200:203], v[80:83], a[24:27]
  v_cvt_pk_bf16_f32 v233, v34, v35
  v_cvt_pk_bf16_f32 v234, v36, v37
  v_mfma_f32_16x16x32_bf16 a[40:43], a[200:203], v[84:87], a[40:43]
  v_mfma_f32_16x16x32_bf16 a[28:31], a[204:207], v[80:83], a[28:31]
  ds_read_b64_tr_b16 a[176:177], v14 offset:16384
  ds_read_b64_tr_b16 a[178:179], v14 offset:20480
  v_mfma_f32_16x16x32_bf16 a[44:47], a[204:207], v[84:87], a[44:47]
  v_exp_f32_e64 v40, v40
  v_mfma_f32_16x16x32_bf16 v[116:119], v[28:31], v[80:83], v[116:119]
  ds_read_b64_tr_b16 a[180:181], v15 offset:16384
  ds_read_b64_tr_b16 a[182:183], v15 offset:20480
  v_mfma_f32_16x16x32_bf16 v[120:123], v[28:31], v[84:87], v[120:123]
  s_waitcnt lgkmcnt(4)
  s_nop 0
  v_mfma_f32_16x16x32_bf16 v[48:51], a[144:147], a[208:211], v[100:103]
  ds_read_b64_tr_b16 a[184:185], v16 offset:16384
  ds_read_b64_tr_b16 a[186:187], v16 offset:20480
  v_mfma_f32_16x16x32_bf16 v[48:51], a[148:151], a[212:215], v[48:51]
  v_exp_f32_e64 v41, v41
  v_mfma_f32_16x16x32_bf16 v[48:51], a[152:155], a[216:219], v[48:51]
  ds_read_b64_tr_b16 a[188:189], v17 offset:16384
  ds_read_b64_tr_b16 a[190:191], v17 offset:20480
  v_mfma_f32_16x16x32_bf16 v[48:51], a[156:159], a[220:223], v[48:51]
  v_exp_f32_e64 v42, v42
  v_mfma_f32_16x16x32_bf16 v[52:55], a[160:163], a[208:211], v[100:103]
  ds_read_b64_tr_b16 a[192:193], v18 offset:16384
  ds_read_b64_tr_b16 a[194:195], v18 offset:20480
  v_mfma_f32_16x16x32_bf16 v[52:55], a[164:167], a[212:215], v[52:55]
  v_exp_f32_e64 v43, v43
  v_mfma_f32_16x16x32_bf16 v[52:55], a[168:171], a[216:219], v[52:55]
  ds_read_b64_tr_b16 a[196:197], v19 offset:16384
  ds_read_b64_tr_b16 a[198:199], v19 offset:20480
  v_mfma_f32_16x16x32_bf16 v[52:55], a[172:175], a[220:223], v[52:55]
  v_cvt_pk_bf16_f32 v235, v38, v39
  v_cvt_pk_bf16_f32 v236, v40, v41
  v_mfma_f32_16x16x32_bf16 v[56:59], a[144:147], a[224:227], v[104:107]
  ds_read_b64_tr_b16 a[200:201], v20 offset:16384
  ds_read_b64_tr_b16 a[202:203], v20 offset:20480
  v_mfma_f32_16x16x32_bf16 v[56:59], a[148:151], a[228:231], v[56:59]
  v_exp_f32_e64 v44, v44
  v_mfma_f32_16x16x32_bf16 v[56:59], a[152:155], a[232:235], v[56:59]
  ds_read_b64_tr_b16 a[204:205], v21 offset:16384
  ds_read_b64_tr_b16 a[206:207], v21 offset:20480
  v_mfma_f32_16x16x32_bf16 v[56:59], a[156:159], a[236:239], v[56:59]
  v_exp_f32_e64 v45, v45
  v_mfma_f32_16x16x32_bf16 v[60:63], a[160:163], a[224:227], v[104:107]
  v_exp_f32_e64 v46, v46
  v_mfma_f32_16x16x32_bf16 v[60:63], a[164:167], a[228:231], v[60:63]
  v_exp_f32_e64 v47, v47
  v_mfma_f32_16x16x32_bf16 v[60:63], a[168:171], a[232:235], v[60:63]
  v_cvt_pk_bf16_f32 v237, v42, v43
  v_cvt_pk_bf16_f32 v238, v44, v45
  v_mfma_f32_16x16x32_bf16 v[60:63], a[172:175], a[236:239], v[60:63]
  v_exp_f32_e64 v48, v48
  v_mfma_f32_16x16x32_bf16 v[32:35], a[144:147], a[240:243], v[108:111]
  v_exp_f32_e64 v49, v49
  v_mfma_f32_16x16x32_bf16 v[32:35], a[148:151], a[244:247], v[32:35]
  v_exp_f32_e64 v50, v50
  v_mfma_f32_16x16x32_bf16 v[32:35], a[152:155], a[248:251], v[32:35]
  v_exp_f32_e64 v51, v51
  v_mfma_f32_16x16x32_bf16 v[32:35], a[156:159], a[252:255], v[32:35]
  v_cvt_pk_bf16_f32 v239, v46, v47
  v_cvt_pk_bf16_f32 v80, v48, v49
  v_mfma_f32_16x16x32_bf16 v[36:39], a[160:163], a[240:243], v[108:111]
  v_exp_f32_e64 v52, v52
  v_mfma_f32_16x16x32_bf16 v[36:39], a[164:167], a[244:247], v[36:39]
  v_exp_f32_e64 v53, v53
  v_mfma_f32_16x16x32_bf16 v[36:39], a[168:171], a[248:251], v[36:39]
  v_exp_f32_e64 v54, v54
  v_mfma_f32_16x16x32_bf16 v[36:39], a[172:175], a[252:255], v[36:39]
  v_exp_f32_e64 v55, v55
  v_mfma_f32_16x16x32_bf16 v[40:43], a[144:147], v[184:187], v[88:91]
  v_cvt_pk_bf16_f32 v81, v50, v51
  v_cvt_pk_bf16_f32 v82, v52, v53
  v_mfma_f32_16x16x32_bf16 v[40:43], a[148:151], v[188:191], v[40:43]
  v_exp_f32_e64 v56, v56
  v_mfma_f32_16x16x32_bf16 v[40:43], a[152:155], v[192:195], v[40:43]
  v_exp_f32_e64 v57, v57
  v_mfma_f32_16x16x32_bf16 v[40:43], a[156:159], v[196:199], v[40:43]
  v_exp_f32_e64 v58, v58
  v_mfma_f32_16x16x32_bf16 v[44:47], a[160:163], v[184:187], v[88:91]
  s_waitcnt vmcnt(0) lgkmcnt(0)
  s_nop 0
  v_mfma_f32_16x16x32_bf16 v[44:47], a[164:167], v[188:191], v[44:47]
  ds_read_b64_tr_b16 a[208:209], v14 offset:24576
  ds_read_b64_tr_b16 a[210:211], v14 offset:28672
  v_mfma_f32_16x16x32_bf16 v[44:47], a[168:171], v[192:195], v[44:47]
  ds_read_b64_tr_b16 a[212:213], v15 offset:24576
  ds_read_b64_tr_b16 a[214:215], v15 offset:28672
  v_mfma_f32_16x16x32_bf16 v[44:47], a[172:175], v[196:199], v[44:47]
  ds_read_b64_tr_b16 a[216:217], v16 offset:24576
  ds_read_b64_tr_b16 a[218:219], v16 offset:28672
  v_mfma_f32_16x16x32_bf16 v[124:127], v[28:31], v[64:67], v[124:127]
  ds_read_b64_tr_b16 a[220:221], v17 offset:24576
  ds_read_b64_tr_b16 a[222:223], v17 offset:28672
  v_mfma_f32_16x16x32_bf16 v[128:131], v[28:31], v[68:71], v[128:131]
  ds_read_b64_tr_b16 a[224:225], v18 offset:24576
  ds_read_b64_tr_b16 a[226:227], v18 offset:28672
  v_mfma_f32_16x16x32_bf16 v[132:135], v[28:31], v[72:75], v[132:135]
  ds_read_b64_tr_b16 a[228:229], v19 offset:24576
  ds_read_b64_tr_b16 a[230:231], v19 offset:28672
  v_mfma_f32_16x16x32_bf16 v[112:115], v[28:31], v[76:79], v[112:115]
  ds_read_b64_tr_b16 a[232:233], v20 offset:24576
  ds_read_b64_tr_b16 a[234:235], v20 offset:28672
  v_mfma_f32_16x16x32_bf16 v[116:119], v[28:31], v[232:235], v[116:119]
  ds_read_b64_tr_b16 a[236:237], v21 offset:24576
  ds_read_b64_tr_b16 a[238:239], v21 offset:28672
  v_mfma_f32_16x16x32_bf16 v[120:123], v[28:31], v[236:239], v[120:123]
  v_cvt_pk_bf16_f32 v83, v54, v55
  v_cvt_pk_bf16_f32 v84, v56, v57
  v_mfma_f32_16x16x32_bf16 a[48:51], a[176:179], v[64:67], a[48:51]
  s_waitcnt lgkmcnt(8)
  s_nop 0
  v_mfma_f32_16x16x32_bf16 a[48:51], a[208:211], v[80:83], a[48:51]
  v_exp_f32_e64 v59, v59
  v_mfma_f32_16x16x32_bf16 a[52:55], a[180:183], v[64:67], a[52:55]
  v_exp_f32_e64 v60, v60
  v_mfma_f32_16x16x32_bf16 a[52:55], a[212:215], v[80:83], a[52:55]
  v_exp_f32_e64 v61, v61
  v_mfma_f32_16x16x32_bf16 a[56:59], a[184:187], v[64:67], a[56:59]
  ds_write_b128 v23, a[48:51] offset:12288
  v_mfma_f32_16x16x32_bf16 a[56:59], a[216:219], v[80:83], a[56:59]
  v_exp_f32_e64 v62, v62
  v_mfma_f32_16x16x32_bf16 a[60:63], a[188:191], v[64:67], a[60:63]
  v_exp_f32_e64 v63, v63
  v_mfma_f32_16x16x32_bf16 a[60:63], a[220:223], v[80:83], a[60:63]
  ds_write_b128 v23, a[52:55] offset:13312
  v_mfma_f32_16x16x32_bf16 a[96:99], a[192:195], v[64:67], a[96:99]
  s_waitcnt lgkmcnt(2)
  s_nop 0
  v_mfma_f32_16x16x32_bf16 a[96:99], a[224:227], v[80:83], a[96:99]
  v_cvt_pk_bf16_f32 v85, v58, v59
  v_cvt_pk_bf16_f32 v86, v60, v61
  v_mfma_f32_16x16x32_bf16 a[100:103], a[196:199], v[64:67], a[100:103]
  ds_write_b128 v23, a[56:59] offset:14336
  v_mfma_f32_16x16x32_bf16 a[100:103], a[228:231], v[80:83], a[100:103]
  v_exp_f32_e64 v32, v32
  v_mfma_f32_16x16x32_bf16 a[104:107], a[200:203], v[64:67], a[104:107]
  v_exp_f32_e64 v33, v33
  v_mfma_f32_16x16x32_bf16 a[104:107], a[232:235], v[80:83], a[104:107]
  ds_write_b128 v23, a[60:63] offset:15360
  v_mfma_f32_16x16x32_bf16 a[108:111], a[204:207], v[64:67], a[108:111]
  v_cvt_pk_bf16_f32 v87, v62, v63
  v_cvt_pk_bf16_f32 v240, v32, v33
  v_mfma_f32_16x16x32_bf16 a[108:111], a[236:239], v[80:83], a[108:111]
  v_exp_f32_e64 v34, v34
  v_mfma_f32_16x16x32_bf16 a[64:67], a[176:179], v[68:71], a[64:67]
  ds_write_b128 v23, a[96:99] offset:24576
  v_mfma_f32_16x16x32_bf16 a[64:67], a[208:211], v[84:87], a[64:67]
  v_exp_f32_e64 v35, v35
  v_mfma_f32_16x16x32_bf16 a[68:71], a[180:183], v[68:71], a[68:71]
  v_exp_f32_e64 v36, v36
  v_mfma_f32_16x16x32_bf16 a[68:71], a[212:215], v[84:87], a[68:71]
  ds_write_b128 v23, a[100:103] offset:25600
  v_mfma_f32_16x16x32_bf16 a[72:75], a[184:187], v[68:71], a[72:75]
  v_exp_f32_e64 v37, v37
  v_mfma_f32_16x16x32_bf16 a[72:75], a[216:219], v[84:87], a[72:75]
  v_exp_f32_e64 v38, v38
  v_mfma_f32_16x16x32_bf16 a[76:79], a[188:191], v[68:71], a[76:79]
  ds_write_b128 v23, a[104:107] offset:26624
  v_mfma_f32_16x16x32_bf16 a[76:79], a[220:223], v[84:87], a[76:79]
  v_exp_f32_e64 v39, v39
  v_mfma_f32_16x16x32_bf16 a[112:115], a[192:195], v[68:71], a[112:115]
  v_cvt_pk_bf16_f32 v241, v34, v35
  v_cvt_pk_bf16_f32 v242, v36, v37
  v_mfma_f32_16x16x32_bf16 a[112:115], a[224:227], v[84:87], a[112:115]
  ds_write_b128 v23, a[108:111] offset:27648
  v_mfma_f32_16x16x32_bf16 a[116:119], a[196:199], v[68:71], a[116:119]
  v_exp_f32_e64 v40, v40
  v_mfma_f32_16x16x32_bf16 a[116:119], a[228:231], v[84:87], a[116:119]
  v_exp_f32_e64 v41, v41
  v_mfma_f32_16x16x32_bf16 a[120:123], a[200:203], v[68:71], a[120:123]
  ds_write_b128 v23, a[64:67] offset:16384
  v_mfma_f32_16x16x32_bf16 a[120:123], a[232:235], v[84:87], a[120:123]
  v_exp_f32_e64 v42, v42
  v_mfma_f32_16x16x32_bf16 a[124:127], a[204:207], v[68:71], a[124:127]
  v_exp_f32_e64 v43, v43
  v_mfma_f32_16x16x32_bf16 a[124:127], a[236:239], v[84:87], a[124:127]
  ds_write_b128 v23, a[68:71] offset:17408
  v_mfma_f32_16x16x32_bf16 v[48:51], a[144:147], v[200:203], v[92:95]
  v_cvt_pk_bf16_f32 v243, v38, v39
  v_cvt_pk_bf16_f32 v244, v40, v41
  v_mfma_f32_16x16x32_bf16 v[48:51], a[148:151], v[204:207], v[48:51]
  v_exp_f32_e64 v44, v44
  v_mfma_f32_16x16x32_bf16 v[48:51], a[152:155], v[208:211], v[48:51]
  ds_write_b128 v23, a[72:75] offset:18432
  v_mfma_f32_16x16x32_bf16 v[48:51], a[156:159], v[212:215], v[48:51]
  v_exp_f32_e64 v45, v45
  v_mfma_f32_16x16x32_bf16 v[52:55], a[160:163], v[200:203], v[92:95]
  v_exp_f32_e64 v46, v46
  v_mfma_f32_16x16x32_bf16 v[52:55], a[164:167], v[204:207], v[52:55]
  ds_write_b128 v23, a[76:79] offset:19456
  v_mfma_f32_16x16x32_bf16 v[52:55], a[168:171], v[208:211], v[52:55]
  v_exp_f32_e64 v47, v47
  v_mfma_f32_16x16x32_bf16 v[52:55], a[172:175], v[212:215], v[52:55]
  v_cvt_pk_bf16_f32 v245, v42, v43
  v_cvt_pk_bf16_f32 v246, v44, v45
  v_mfma_f32_16x16x32_bf16 v[56:59], a[144:147], v[216:219], v[96:99]
  ds_write_b128 v23, a[112:115] offset:28672
  v_mfma_f32_16x16x32_bf16 v[56:59], a[148:151], v[220:223], v[56:59]
  v_exp_f32_e64 v48, v48
  v_mfma_f32_16x16x32_bf16 v[56:59], a[152:155], v[224:227], v[56:59]
  v_exp_f32_e64 v49, v49
  v_mfma_f32_16x16x32_bf16 v[56:59], a[156:159], v[228:231], v[56:59]
  ds_write_b128 v23, a[116:119] offset:29696
  v_mfma_f32_16x16x32_bf16 v[60:63], a[160:163], v[216:219], v[96:99]
  v_exp_f32_e64 v50, v50
  v_mfma_f32_16x16x32_bf16 v[60:63], a[164:167], v[220:223], v[60:63]
  v_exp_f32_e64 v51, v51
  v_mfma_f32_16x16x32_bf16 v[60:63], a[168:171], v[224:227], v[60:63]
  ds_write_b128 v23, a[120:123] offset:30720
  v_mfma_f32_16x16x32_bf16 v[60:63], a[172:175], v[228:231], v[60:63]
  v_cvt_pk_bf16_f32 v247, v46, v47
  v_cvt_pk_bf16_f32 v248, v48, v49
  v_mfma_f32_16x16x32_bf16 a[80:83], a[176:179], v[72:75], a[80:83]
  v_exp_f32_e64 v52, v52
  v_mfma_f32_16x16x32_bf16 a[80:83], a[208:211], v[240:243], a[80:83]
  ds_write_b128 v23, a[124:127] offset:31744
  v_mfma_f32_16x16x32_bf16 a[84:87], a[180:183], v[72:75], a[84:87]
  v_exp_f32_e64 v53, v53
  v_mfma_f32_16x16x32_bf16 a[84:87], a[212:215], v[240:243], a[84:87]
  v_exp_f32_e64 v54, v54
  v_mfma_f32_16x16x32_bf16 a[88:91], a[184:187], v[72:75], a[88:91]
  ds_write_b128 v23, a[80:83] offset:20480
  v_mfma_f32_16x16x32_bf16 a[88:91], a[216:219], v[240:243], a[88:91]
  v_exp_f32_e64 v55, v55
  v_mfma_f32_16x16x32_bf16 a[92:95], a[188:191], v[72:75], a[92:95]
  v_cvt_pk_bf16_f32 v249, v50, v51
  v_cvt_pk_bf16_f32 v250, v52, v53
  v_mfma_f32_16x16x32_bf16 a[92:95], a[220:223], v[240:243], a[92:95]
  ds_write_b128 v23, a[84:87] offset:21504
  v_mfma_f32_16x16x32_bf16 a[128:131], a[192:195], v[72:75], a[128:131]
  v_exp_f32_e64 v56, v56
  v_mfma_f32_16x16x32_bf16 a[128:131], a[224:227], v[240:243], a[128:131]
  v_exp_f32_e64 v57, v57
  v_mfma_f32_16x16x32_bf16 a[132:135], a[196:199], v[72:75], a[132:135]
  ds_write_b128 v23, a[88:91] offset:22528
  v_mfma_f32_16x16x32_bf16 a[132:135], a[228:231], v[240:243], a[132:135]
  v_exp_f32_e64 v58, v58
  v_mfma_f32_16x16x32_bf16 a[136:139], a[200:203], v[72:75], a[136:139]
  v_exp_f32_e64 v59, v59
  v_mfma_f32_16x16x32_bf16 a[136:139], a[232:235], v[240:243], a[136:139]
  ds_write_b128 v23, a[92:95] offset:23552
  v_mfma_f32_16x16x32_bf16 a[140:143], a[204:207], v[72:75], a[140:143]
  v_cvt_pk_bf16_f32 v251, v54, v55
  v_cvt_pk_bf16_f32 v252, v56, v57
  v_mfma_f32_16x16x32_bf16 a[140:143], a[236:239], v[240:243], a[140:143]
  v_exp_f32_e64 v60, v60
  v_mfma_f32_16x16x32_bf16 a[0:3], a[192:195], v[76:79], a[0:3]
  ds_write_b128 v27, a[128:131] offset:0
  v_mfma_f32_16x16x32_bf16 a[0:3], a[224:227], v[244:247], a[0:3]
  v_exp_f32_e64 v61, v61
  v_mfma_f32_16x16x32_bf16 a[4:7], a[196:199], v[76:79], a[4:7]
  v_exp_f32_e64 v62, v62
  v_mfma_f32_16x16x32_bf16 a[4:7], a[228:231], v[244:247], a[4:7]
  ds_write_b128 v27, a[132:135] offset:1024
  v_mfma_f32_16x16x32_bf16 a[8:11], a[200:203], v[76:79], a[8:11]
  v_exp_f32_e64 v63, v63
  v_mfma_f32_16x16x32_bf16 a[8:11], a[232:235], v[244:247], a[8:11]
  v_cvt_pk_bf16_f32 v253, v58, v59
  v_cvt_pk_bf16_f32 v254, v60, v61
  v_mfma_f32_16x16x32_bf16 a[12:15], a[204:207], v[76:79], a[12:15]
  ds_write_b128 v27, a[136:139] offset:2048
  v_mfma_f32_16x16x32_bf16 a[12:15], a[236:239], v[244:247], a[12:15]
  v_cvt_pk_bf16_f32 v255, v62, v63
  v_mfma_f32_16x16x32_bf16 a[16:19], a[192:195], v[232:235], a[16:19]
  v_mfma_f32_16x16x32_bf16 a[16:19], a[224:227], v[248:251], a[16:19]
  ds_write_b128 v27, a[140:143] offset:3072
  v_mfma_f32_16x16x32_bf16 a[20:23], a[196:199], v[232:235], a[20:23]
  v_mfma_f32_16x16x32_bf16 a[20:23], a[228:231], v[248:251], a[20:23]
  v_mfma_f32_16x16x32_bf16 a[24:27], a[200:203], v[232:235], a[24:27]
  ds_write_b128 v23, a[0:3] offset:0
  v_mfma_f32_16x16x32_bf16 a[24:27], a[232:235], v[248:251], a[24:27]
  v_mfma_f32_16x16x32_bf16 a[28:31], a[204:207], v[232:235], a[28:31]
  v_mfma_f32_16x16x32_bf16 a[28:31], a[236:239], v[248:251], a[28:31]
  ds_write_b128 v23, a[4:7] offset:1024
  v_mfma_f32_16x16x32_bf16 a[32:35], a[192:195], v[236:239], a[32:35]
  v_mfma_f32_16x16x32_bf16 a[32:35], a[224:227], v[252:255], a[32:35]
  v_mfma_f32_16x16x32_bf16 a[36:39], a[196:199], v[236:239], a[36:39]
  ds_write_b128 v23, a[8:11] offset:2048
  v_mfma_f32_16x16x32_bf16 a[36:39], a[228:231], v[252:255], a[36:39]
  v_mfma_f32_16x16x32_bf16 a[40:43], a[200:203], v[236:239], a[40:43]
  v_xor_b32 v7, 24576, v27
  v_and_b32 v10, 0xfffffcff, v27
  v_mfma_f32_16x16x32_bf16 a[40:43], a[232:235], v[252:255], a[40:43]
  ds_write_b128 v23, a[12:15] offset:3072
  v_mfma_f32_16x16x32_bf16 a[44:47], a[204:207], v[236:239], a[44:47]
  v_xor_b32 v11, 8192, v10
  v_xor_b32 v12, 16384, v10
  v_mfma_f32_16x16x32_bf16 a[44:47], a[236:239], v[252:255], a[44:47]
  v_xor_b32 v13, 24576, v10
  s_add_u32 s56, s53, 0
  s_nop 0
  v_mfma_f32_16x16x32_bf16 v[124:127], v[28:31], v[80:83], v[124:127]
  ds_write_b128 v23, a[16:19] offset:4096
  v_mfma_f32_16x16x32_bf16 v[128:131], v[28:31], v[84:87], v[128:131]
  s_add_u32 s57, s53, 4096
  s_add_u32 s58, s53, 8192
  v_mfma_f32_16x16x32_bf16 v[132:135], v[28:31], v[240:243], v[132:135]
  v_mfma_f32_16x16x32_bf16 v[112:115], v[28:31], v[244:247], v[112:115]
  ds_write_b128 v23, a[20:23] offset:5120
  v_mfma_f32_16x16x32_bf16 v[116:119], v[28:31], v[248:251], v[116:119]
  v_mfma_f32_16x16x32_bf16 v[120:123], v[28:31], v[252:255], v[120:123]
  v_mfma_f32_16x16x32_bf16 v[136:139], a[176:179], v[76:79], v[136:139]
  ds_write_b128 v23, a[24:27] offset:6144
  v_mfma_f32_16x16x32_bf16 v[136:139], a[208:211], v[244:247], v[136:139]
  v_mfma_f32_16x16x32_bf16 v[140:143], a[180:183], v[76:79], v[140:143]
  v_mov_b32 v32, v112
  v_mov_b32 v36, v124
  v_mfma_f32_16x16x32_bf16 v[140:143], a[212:215], v[244:247], v[140:143]
  ds_write_b128 v23, a[28:31] offset:7168
  v_mfma_f32_16x16x32_bf16 v[144:147], a[184:187], v[76:79], v[144:147]
  v_mov_b32 v33, v116
  v_mov_b32 v37, v128
  v_mfma_f32_16x16x32_bf16 v[144:147], a[216:219], v[244:247], v[144:147]
  v_mov_b32 v34, v120
  v_mov_b32 v38, v132
  v_mfma_f32_16x16x32_bf16 v[148:151], a[188:191], v[76:79], v[148:151]
  ds_write_b128 v23, a[32:35] offset:8192
  v_mfma_f32_16x16x32_bf16 v[148:151], a[220:223], v[244:247], v[148:151]
  v_add_f32 v35, v32, v33
  v_add_f32 v39, v34, v36
  v_mfma_f32_16x16x32_bf16 v[152:155], a[176:179], v[232:235], v[152:155]
  v_add_f32 v40, v37, v38
  v_add_f32 v35, v35, v39
  v_mfma_f32_16x16x32_bf16 v[152:155], a[208:211], v[248:251], v[152:155]
  ds_write_b128 v23, a[36:39] offset:9216
  v_mfma_f32_16x16x32_bf16 v[156:159], a[180:183], v[232:235], v[156:159]
  v_add_f32 v35, v35, v40
  v_mov_b32 v39, v35
  v_mfma_f32_16x16x32_bf16 v[156:159], a[212:215], v[248:251], v[156:159]
  ds_write_b128 v27, v[32:35] offset:4096
  v_mfma_f32_16x16x32_bf16 v[160:163], a[184:187], v[232:235], v[160:163]
  ds_write_b128 v23, a[40:43] offset:10240
  v_mfma_f32_16x16x32_bf16 v[160:163], a[216:219], v[248:251], v[160:163]
  ds_write_b128 v27, v[36:39] offset:5120
  v_mfma_f32_16x16x32_bf16 v[164:167], a[188:191], v[232:235], v[164:167]
  v_mfma_f32_16x16x32_bf16 v[164:167], a[220:223], v[248:251], v[164:167]
  ds_write_b128 v23, a[44:47] offset:11264
  v_mfma_f32_16x16x32_bf16 v[168:171], a[176:179], v[236:239], v[168:171]
  v_mfma_f32_16x16x32_bf16 v[168:171], a[208:211], v[252:255], v[168:171]
  v_mfma_f32_16x16x32_bf16 v[172:175], a[180:183], v[236:239], v[172:175]
  v_mfma_f32_16x16x32_bf16 v[172:175], a[212:215], v[252:255], v[172:175]
  v_mfma_f32_16x16x32_bf16 v[176:179], a[184:187], v[236:239], v[176:179]
  v_mfma_f32_16x16x32_bf16 v[176:179], a[216:219], v[252:255], v[176:179]
  v_mfma_f32_16x16x32_bf16 v[180:183], a[188:191], v[236:239], v[180:183]
  v_mfma_f32_16x16x32_bf16 v[180:183], a[220:223], v[252:255], v[180:183]
  s_waitcnt lgkmcnt(0)
  s_barrier
  ds_read_b128 v[232:235], v10 offset:4096
  ds_read_b128 v[240:243], v11 offset:4096
  ds_read_b128 v[244:247], v12 offset:5120
  ds_read_b128 v[248:251], v13 offset:5120
  ds_read_b128 v[32:35], v25 offset:12288
  ds_read_b128 v[36:39], v25 offset:13312
  ds_read_b128 v[40:43], v26 offset:24576
  ds_read_b128 v[44:47], v26 offset:25600
  ds_read_b128 v[48:51], v24 offset:0
  ds_read_b128 v[52:55], v24 offset:1024
  s_waitcnt lgkmcnt(6)
  s_nop 0
  v_pk_add_f32 v[232:233], v[232:233], v[240:241]
  v_pk_add_f32 v[234:235], v[234:235], v[242:243]
  v_pk_add_f32 v[244:245], v[244:245], v[248:249]
  v_pk_add_f32 v[246:247], v[246:247], v[250:251]
  v_pk_add_f32 v[232:233], v[232:233], v[244:245]
  v_pk_add_f32 v[234:235], v[234:235], v[246:247]
  v_rcp_f32 v240, v232
  v_rcp_f32 v242, v233
  v_rcp_f32 v244, v234
  v_cmp_nge_f32 vcc, s39, v235
  s_cmp_eq_u32 s38, 0
  s_cselect_b64 s[40:41], vcc, 0
  s_cmp_lg_u64 s[40:41], 0
  s_cbranch_scc1 L_fallback
  ds_read_b128 v[56:59], v25 offset:14336
  ds_read_b128 v[60:63], v25 offset:15360
  ds_read_b128 v[64:67], v26 offset:26624
  ds_read_b128 v[68:71], v26 offset:27648
  ds_read_b128 v[72:75], v24 offset:2048
  ds_read_b128 v[76:79], v24 offset:3072
  s_waitcnt lgkmcnt(6)
  s_nop 0
  v_pk_add_f32 v[136:137], v[136:137], v[32:33]
  v_pk_add_f32 v[138:139], v[138:139], v[34:35]
  v_pk_add_f32 v[140:141], v[140:141], v[36:37]
  v_pk_add_f32 v[142:143], v[142:143], v[38:39]
  v_pk_add_f32 v[40:41], v[40:41], v[48:49]
  v_pk_add_f32 v[42:43], v[42:43], v[50:51]
  v_pk_add_f32 v[44:45], v[44:45], v[52:53]
  v_pk_add_f32 v[46:47], v[46:47], v[54:55]
  v_pk_add_f32 v[136:137], v[136:137], v[40:41]
  v_pk_add_f32 v[138:139], v[138:139], v[42:43]
  v_pk_add_f32 v[140:141], v[140:141], v[44:45]
  v_pk_add_f32 v[142:143], v[142:143], v[46:47]
  v_pk_mul_f32 v[136:137], v[136:137], v[240:241] op_sel_hi:[1,0]
  v_pk_mul_f32 v[138:139], v[138:139], v[240:241] op_sel_hi:[1,0]
  v_pk_mul_f32 v[140:141], v[140:141], v[240:241] op_sel_hi:[1,0]
  v_pk_mul_f32 v[142:143], v[142:143], v[240:241] op_sel_hi:[1,0]
  v_cvt_pk_bf16_f32 v88, v136, v137
  v_cvt_pk_bf16_f32 v90, v140, v141
  v_cvt_pk_bf16_f32 v89, v138, v139
  v_cvt_pk_bf16_f32 v91, v142, v143
  v_permlane16_swap_b32 v88, v90
  s_nop 0
  v_permlane16_swap_b32 v89, v91
  s_nop 0
  buffer_store_dwordx4 v[88:91], v22, s[24:27], s56 offen offset:0 sc1
  ds_read_b128 v[184:187], v25 offset:16384
  ds_read_b128 v[188:191], v25 offset:17408
  ds_read_b128 v[192:195], v26 offset:28672
  ds_read_b128 v[196:199], v26 offset:29696
  ds_read_b128 v[200:203], v24 offset:4096
  ds_read_b128 v[204:207], v24 offset:5120
  s_waitcnt lgkmcnt(6)
  s_nop 0
  v_pk_add_f32 v[144:145], v[144:145], v[56:57]
  v_pk_add_f32 v[146:147], v[146:147], v[58:59]
  v_pk_add_f32 v[148:149], v[148:149], v[60:61]
  v_pk_add_f32 v[150:151], v[150:151], v[62:63]
  v_pk_add_f32 v[64:65], v[64:65], v[72:73]
  v_pk_add_f32 v[66:67], v[66:67], v[74:75]
  v_pk_add_f32 v[68:69], v[68:69], v[76:77]
  v_pk_add_f32 v[70:71], v[70:71], v[78:79]
  v_pk_add_f32 v[144:145], v[144:145], v[64:65]
  v_pk_add_f32 v[146:147], v[146:147], v[66:67]
  v_pk_add_f32 v[148:149], v[148:149], v[68:69]
  v_pk_add_f32 v[150:151], v[150:151], v[70:71]
  v_pk_mul_f32 v[144:145], v[144:145], v[240:241] op_sel_hi:[1,0]
  v_pk_mul_f32 v[146:147], v[146:147], v[240:241] op_sel_hi:[1,0]
  v_pk_mul_f32 v[148:149], v[148:149], v[240:241] op_sel_hi:[1,0]
  v_pk_mul_f32 v[150:151], v[150:151], v[240:241] op_sel_hi:[1,0]
  v_cvt_pk_bf16_f32 v92, v144, v145
  v_cvt_pk_bf16_f32 v94, v148, v149
  v_cvt_pk_bf16_f32 v93, v146, v147
  v_cvt_pk_bf16_f32 v95, v150, v151
  v_permlane16_swap_b32 v92, v94
  s_nop 0
  v_permlane16_swap_b32 v93, v95
  s_nop 0
  buffer_store_dwordx4 v[92:95], v22, s[24:27], s56 offen offset:64 sc1
  ds_read_b128 v[208:211], v25 offset:18432
  ds_read_b128 v[212:215], v25 offset:19456
  ds_read_b128 v[216:219], v26 offset:30720
  ds_read_b128 v[220:223], v26 offset:31744
  ds_read_b128 v[224:227], v24 offset:6144
  ds_read_b128 v[228:231], v24 offset:7168
  s_waitcnt lgkmcnt(6)
  s_nop 0
  v_pk_add_f32 v[152:153], v[152:153], v[184:185]
  v_pk_add_f32 v[154:155], v[154:155], v[186:187]
  v_pk_add_f32 v[156:157], v[156:157], v[188:189]
  v_pk_add_f32 v[158:159], v[158:159], v[190:191]
  v_pk_add_f32 v[192:193], v[192:193], v[200:201]
  v_pk_add_f32 v[194:195], v[194:195], v[202:203]
  v_pk_add_f32 v[196:197], v[196:197], v[204:205]
  v_pk_add_f32 v[198:199], v[198:199], v[206:207]
  v_pk_add_f32 v[152:153], v[152:153], v[192:193]
  v_pk_add_f32 v[154:155], v[154:155], v[194:195]
  v_pk_add_f32 v[156:157], v[156:157], v[196:197]
  v_pk_add_f32 v[158:159], v[158:159], v[198:199]
  v_pk_mul_f32 v[152:153], v[152:153], v[242:243] op_sel_hi:[1,0]
  v_pk_mul_f32 v[154:155], v[154:155], v[242:243] op_sel_hi:[1,0]
  v_pk_mul_f32 v[156:157], v[156:157], v[242:243] op_sel_hi:[1,0]
  v_pk_mul_f32 v[158:159], v[158:159], v[242:243] op_sel_hi:[1,0]
  v_cvt_pk_bf16_f32 v96, v152, v153
  v_cvt_pk_bf16_f32 v98, v156, v157
  v_cvt_pk_bf16_f32 v97, v154, v155
  v_cvt_pk_bf16_f32 v99, v158, v159
  v_permlane16_swap_b32 v96, v98
  s_nop 0
  v_permlane16_swap_b32 v97, v99
  s_nop 0
  buffer_store_dwordx4 v[96:99], v22, s[24:27], s57 offen offset:0 sc1
  ds_read_b128 v[32:35], v25 offset:20480
  ds_read_b128 v[36:39], v25 offset:21504
  ds_read_b128 v[40:43], v7 offset:0
  ds_read_b128 v[44:47], v7 offset:1024
  ds_read_b128 v[48:51], v24 offset:8192
  ds_read_b128 v[52:55], v24 offset:9216
  s_waitcnt lgkmcnt(6)
  s_nop 0
  v_pk_add_f32 v[160:161], v[160:161], v[208:209]
  v_pk_add_f32 v[162:163], v[162:163], v[210:211]
  v_pk_add_f32 v[164:165], v[164:165], v[212:213]
  v_pk_add_f32 v[166:167], v[166:167], v[214:215]
  v_pk_add_f32 v[216:217], v[216:217], v[224:225]
  v_pk_add_f32 v[218:219], v[218:219], v[226:227]
  v_pk_add_f32 v[220:221], v[220:221], v[228:229]
  v_pk_add_f32 v[222:223], v[222:223], v[230:231]
  v_pk_add_f32 v[160:161], v[160:161], v[216:217]
  v_pk_add_f32 v[162:163], v[162:163], v[218:219]
  v_pk_add_f32 v[164:165], v[164:165], v[220:221]
  v_pk_add_f32 v[166:167], v[166:167], v[222:223]
  v_pk_mul_f32 v[160:161], v[160:161], v[242:243] op_sel_hi:[1,0]
  v_pk_mul_f32 v[162:163], v[162:163], v[242:243] op_sel_hi:[1,0]
  v_pk_mul_f32 v[164:165], v[164:165], v[242:243] op_sel_hi:[1,0]
  v_pk_mul_f32 v[166:167], v[166:167], v[242:243] op_sel_hi:[1,0]
  v_cvt_pk_bf16_f32 v100, v160, v161
  v_cvt_pk_bf16_f32 v102, v164, v165
  v_cvt_pk_bf16_f32 v101, v162, v163
  v_cvt_pk_bf16_f32 v103, v166, v167
  v_permlane16_swap_b32 v100, v102
  s_nop 0
  v_permlane16_swap_b32 v101, v103
  s_nop 0
  buffer_store_dwordx4 v[100:103], v22, s[24:27], s57 offen offset:64 sc1
  ds_read_b128 v[56:59], v25 offset:22528
  ds_read_b128 v[60:63], v25 offset:23552
  ds_read_b128 v[64:67], v7 offset:2048
  ds_read_b128 v[68:71], v7 offset:3072
  ds_read_b128 v[72:75], v24 offset:10240
  ds_read_b128 v[76:79], v24 offset:11264
  s_waitcnt lgkmcnt(6)
  s_nop 0
  v_pk_add_f32 v[168:169], v[168:169], v[32:33]
  v_pk_add_f32 v[170:171], v[170:171], v[34:35]
  v_pk_add_f32 v[172:173], v[172:173], v[36:37]
  v_pk_add_f32 v[174:175], v[174:175], v[38:39]
  v_pk_add_f32 v[40:41], v[40:41], v[48:49]
  v_pk_add_f32 v[42:43], v[42:43], v[50:51]
  v_pk_add_f32 v[44:45], v[44:45], v[52:53]
  v_pk_add_f32 v[46:47], v[46:47], v[54:55]
  v_pk_add_f32 v[168:169], v[168:169], v[40:41]
  v_pk_add_f32 v[170:171], v[170:171], v[42:43]
  v_pk_add_f32 v[172:173], v[172:173], v[44:45]
  v_pk_add_f32 v[174:175], v[174:175], v[46:47]
  v_pk_mul_f32 v[168:169], v[168:169], v[244:245] op_sel_hi:[1,0]
  v_pk_mul_f32 v[170:171], v[170:171], v[244:245] op_sel_hi:[1,0]
  v_pk_mul_f32 v[172:173], v[172:173], v[244:245] op_sel_hi:[1,0]
  v_pk_mul_f32 v[174:175], v[174:175], v[244:245] op_sel_hi:[1,0]
  v_cvt_pk_bf16_f32 v104, v168, v169
  v_cvt_pk_bf16_f32 v106, v172, v173
  v_cvt_pk_bf16_f32 v105, v170, v171
  v_cvt_pk_bf16_f32 v107, v174, v175
  v_permlane16_swap_b32 v104, v106
  s_nop 0
  v_permlane16_swap_b32 v105, v107
  s_nop 0
  buffer_store_dwordx4 v[104:107], v22, s[24:27], s58 offen offset:0 sc1
  s_waitcnt lgkmcnt(0)
  s_nop 0
  v_pk_add_f32 v[176:177], v[176:177], v[56:57]
  v_pk_add_f32 v[178:179], v[178:179], v[58:59]
  v_pk_add_f32 v[180:181], v[180:181], v[60:61]
  v_pk_add_f32 v[182:183], v[182:183], v[62:63]
  v_pk_add_f32 v[64:65], v[64:65], v[72:73]
  v_pk_add_f32 v[66:67], v[66:67], v[74:75]
  v_pk_add_f32 v[68:69], v[68:69], v[76:77]
  v_pk_add_f32 v[70:71], v[70:71], v[78:79]
  v_pk_add_f32 v[176:177], v[176:177], v[64:65]
  v_pk_add_f32 v[178:179], v[178:179], v[66:67]
  v_pk_add_f32 v[180:181], v[180:181], v[68:69]
  v_pk_add_f32 v[182:183], v[182:183], v[70:71]
  v_pk_mul_f32 v[176:177], v[176:177], v[244:245] op_sel_hi:[1,0]
  v_pk_mul_f32 v[178:179], v[178:179], v[244:245] op_sel_hi:[1,0]
  v_pk_mul_f32 v[180:181], v[180:181], v[244:245] op_sel_hi:[1,0]
  v_pk_mul_f32 v[182:183], v[182:183], v[244:245] op_sel_hi:[1,0]
  v_cvt_pk_bf16_f32 v108, v176, v177
  v_cvt_pk_bf16_f32 v110, v180, v181
  v_cvt_pk_bf16_f32 v109, v178, v179
  v_cvt_pk_bf16_f32 v111, v182, v183
  v_permlane16_swap_b32 v108, v110
  s_nop 0
  v_permlane16_swap_b32 v109, v111
  s_nop 0
  buffer_store_dwordx4 v[108:111], v22, s[24:27], s58 offen offset:64 sc1
L_end:
  s_endpgm
  s_nop 0
L_fallback:
  s_waitcnt vmcnt(0) lgkmcnt(0)
  s_barrier
  s_mov_b32 s38, 1
  v_and_b32 v2, 63, v0
  v_lshrrev_b32 v237, 4, v2
  v_and_b32 v238, 15, v2
  v_xor_b32_e64 v5, 64, v4
  v_add_u32 v5, 31744, v5
  v_xor_b32 v6, 128, v4
  v_add_u32 v6, 63488, v6
  v_xor_b32 v7, 192, v4
  v_add_u32 v7, 95232, v7
  s_branch L_restart
  s_nop 0
L_maxpass:
  s_mov_b32 s38, 2
  s_nop 0
  ds_read_b128 v[184:187], v136 offset:0
  ds_read_b128 v[188:191], v137 offset:0
  ds_read_b128 v[192:195], v138 offset:0
  ds_read_b128 v[196:199], v139 offset:0
  ds_read_b128 v[200:203], v136 offset:4096
  ds_read_b128 v[204:207], v137 offset:4096
  ds_read_b128 v[208:211], v138 offset:4096
  ds_read_b128 v[212:215], v139 offset:4096
  ds_read_b128 v[216:219], v136 offset:8192
  ds_read_b128 v[220:223], v137 offset:8192
  ds_read_b128 v[224:227], v138 offset:8192
  ds_read_b128 v[228:231], v139 offset:8192
  ds_read_b128 a[208:211], v140 offset:0
  ds_read_b128 a[212:215], v141 offset:0
  ds_read_b128 a[216:219], v142 offset:0
  ds_read_b128 a[220:223], v143 offset:0
  ds_read_b128 a[224:227], v140 offset:4096
  ds_read_b128 a[228:231], v141 offset:4096
  ds_read_b128 a[232:235], v142 offset:4096
  ds_read_b128 a[236:239], v143 offset:4096
  ds_read_b128 a[240:243], v140 offset:8192
  ds_read_b128 a[244:247], v141 offset:8192
  ds_read_b128 a[248:251], v142 offset:8192
  ds_read_b128 a[252:255], v143 offset:8192
  v_mov_b32 v240, 0
  v_mov_b32 v241, 0
  v_mov_b32 v242, 0
  v_mov_b32 v243, 0
  v_mov_b32 v244, 0
  v_mov_b32 v245, 0
  v_mov_b32 v246, 0
  v_mov_b32 v247, 0
  v_mov_b32 v248, 0
  v_mov_b32 v249, 0
  v_mov_b32 v250, 0
  v_mov_b32 v251, 0
  v_mov_b32 v252, 0
  v_mov_b32 v253, 0
  v_mov_b32 v254, 0
  v_mov_b32 v255, 0
  v_mov_b32 v80, 0xff800000
  v_mov_b32 v81, 0xff800000
  v_mov_b32 v82, 0xff800000
  v_mov_b32 v83, 0xff800000
  v_mov_b32 v84, 0xff800000
  v_mov_b32 v85, 0xff800000
  v_mov_b32 v86, 0xff800000
  v_mov_b32 v87, 0xff800000
  s_waitcnt vmcnt(0) lgkmcnt(0)
  s_mov_b32 s40, s52
  s_mov_b32 s42, 0
  s_nop 0
L_fb_loop:
  s_add_u32 m0, s35, 0
  s_add_u32 s43, s40, 0
  buffer_load_dwordx4 v4, s[16:19], s43 offen offset:0 lds
  buffer_load_dwordx4 v5, s[16:19], s43 offen offset:1024 lds
  buffer_load_dwordx4 v6, s[16:19], s43 offen offset:2048 lds
  buffer_load_dwordx4 v7, s[16:19], s43 offen offset:3072 lds
  s_add_u32 m0, s35, 4096
  s_add_u32 s43, s40, 131072
  buffer_load_dwordx4 v4, s[16:19], s43 offen offset:0 lds
  buffer_load_dwordx4 v5, s[16:19], s43 offen offset:1024 lds
  buffer_load_dwordx4 v6, s[16:19], s43 offen offset:2048 lds
  buffer_load_dwordx4 v7, s[16:19], s43 offen offset:3072 lds
  s_waitcnt vmcnt(0)
  s_nop 0
  ds_read_b128 a[144:147], v10 offset:0
  ds_read_b128 a[148:151], v11 offset:0
  ds_read_b128 a[152:155], v12 offset:0
  ds_read_b128 a[156:159], v13 offset:0
  ds_read_b128 a[160:163], v10 offset:4096
  ds_read_b128 a[164:167], v11 offset:4096
  ds_read_b128 a[168:171], v12 offset:4096
  ds_read_b128 a[172:175], v13 offset:4096
  s_waitcnt lgkmcnt(0)
  s_nop 0
  v_mfma_f32_16x16x32_bf16 v[32:35], a[144:147], v[184:187], 0
  v_mfma_f32_16x16x32_bf16 v[32:35], a[148:151], v[188:191], v[32:35]
  v_mfma_f32_16x16x32_bf16 v[32:35], a[152:155], v[192:195], v[32:35]
  v_mfma_f32_16x16x32_bf16 v[32:35], a[156:159], v[196:199], v[32:35]
  v_mfma_f32_16x16x32_bf16 v[36:39], a[160:163], v[184:187], 0
  v_mfma_f32_16x16x32_bf16 v[36:39], a[164:167], v[188:191], v[36:39]
  v_mfma_f32_16x16x32_bf16 v[36:39], a[168:171], v[192:195], v[36:39]
  v_mfma_f32_16x16x32_bf16 v[36:39], a[172:175], v[196:199], v[36:39]
  v_mfma_f32_16x16x32_bf16 v[40:43], a[144:147], v[200:203], 0
  v_mfma_f32_16x16x32_bf16 v[40:43], a[148:151], v[204:207], v[40:43]
  v_mfma_f32_16x16x32_bf16 v[40:43], a[152:155], v[208:211], v[40:43]
  v_mfma_f32_16x16x32_bf16 v[40:43], a[156:159], v[212:215], v[40:43]
  v_mfma_f32_16x16x32_bf16 v[44:47], a[160:163], v[200:203], 0
  v_mfma_f32_16x16x32_bf16 v[44:47], a[164:167], v[204:207], v[44:47]
  v_mfma_f32_16x16x32_bf16 v[44:47], a[168:171], v[208:211], v[44:47]
  v_mfma_f32_16x16x32_bf16 v[44:47], a[172:175], v[212:215], v[44:47]
  v_mfma_f32_16x16x32_bf16 v[48:51], a[144:147], v[216:219], 0
  v_mfma_f32_16x16x32_bf16 v[48:51], a[148:151], v[220:223], v[48:51]
  v_mfma_f32_16x16x32_bf16 v[48:51], a[152:155], v[224:227], v[48:51]
  v_mfma_f32_16x16x32_bf16 v[48:51], a[156:159], v[228:231], v[48:51]
  v_mfma_f32_16x16x32_bf16 v[52:55], a[160:163], v[216:219], 0
  v_mfma_f32_16x16x32_bf16 v[52:55], a[164:167], v[220:223], v[52:55]
  v_mfma_f32_16x16x32_bf16 v[52:55], a[168:171], v[224:227], v[52:55]
  v_mfma_f32_16x16x32_bf16 v[52:55], a[172:175], v[228:231], v[52:55]
  v_mfma_f32_16x16x32_bf16 v[56:59], a[144:147], a[208:211], 0
  v_mfma_f32_16x16x32_bf16 v[56:59], a[148:151], a[212:215], v[56:59]
  v_mfma_f32_16x16x32_bf16 v[56:59], a[152:155], a[216:219], v[56:59]
  v_mfma_f32_16x16x32_bf16 v[56:59], a[156:159], a[220:223], v[56:59]
  v_mfma_f32_16x16x32_bf16 v[60:63], a[160:163], a[208:211], 0
  v_mfma_f32_16x16x32_bf16 v[60:63], a[164:167], a[212:215], v[60:63]
  v_mfma_f32_16x16x32_bf16 v[60:63], a[168:171], a[216:219], v[60:63]
  v_mfma_f32_16x16x32_bf16 v[60:63], a[172:175], a[220:223], v[60:63]
  v_mfma_f32_16x16x32_bf16 v[64:67], a[144:147], a[224:227], 0
  v_mfma_f32_16x16x32_bf16 v[64:67], a[148:151], a[228:231], v[64:67]
  v_mfma_f32_16x16x32_bf16 v[64:67], a[152:155], a[232:235], v[64:67]
  v_mfma_f32_16x16x32_bf16 v[64:67], a[156:159], a[236:239], v[64:67]
  v_mfma_f32_16x16x32_bf16 v[68:71], a[160:163], a[224:227], 0
  v_mfma_f32_16x16x32_bf16 v[68:71], a[164:167], a[228:231], v[68:71]
  v_mfma_f32_16x16x32_bf16 v[68:71], a[168:171], a[232:235], v[68:71]
  v_mfma_f32_16x16x32_bf16 v[68:71], a[172:175], a[236:239], v[68:71]
  v_mfma_f32_16x16x32_bf16 v[72:75], a[144:147], a[240:243], 0
  v_mfma_f32_16x16x32_bf16 v[72:75], a[148:151], a[244:247], v[72:75]
  v_mfma_f32_16x16x32_bf16 v[72:75], a[152:155], a[248:251], v[72:75]
  v_mfma_f32_16x16x32_bf16 v[72:75], a[156:159], a[252:255], v[72:75]
  v_mfma_f32_16x16x32_bf16 v[76:79], a[160:163], a[240:243], 0
  v_mfma_f32_16x16x32_bf16 v[76:79], a[164:167], a[244:247], v[76:79]
  v_mfma_f32_16x16x32_bf16 v[76:79], a[168:171], a[248:251], v[76:79]
  v_mfma_f32_16x16x32_bf16 v[76:79], a[172:175], a[252:255], v[76:79]
  s_nop 15
  s_nop 0
  v_max3_f32 v80, v32, v33, v80
  v_max3_f32 v80, v34, v35, v80
  v_max3_f32 v80, v36, v37, v80
  v_max3_f32 v80, v38, v39, v80
  v_max3_f32 v81, v40, v41, v81
  v_max3_f32 v81, v42, v43, v81
  v_max3_f32 v81, v44, v45, v81
  v_max3_f32 v81, v46, v47, v81
  v_max3_f32 v82, v48, v49, v82
  v_max3_f32 v82, v50, v51, v82
  v_max3_f32 v82, v52, v53, v82
  v_max3_f32 v82, v54, v55, v82
  v_max3_f32 v84, v56, v57, v84
  v_max3_f32 v84, v58, v59, v84
  v_max3_f32 v84, v60, v61, v84
  v_max3_f32 v84, v62, v63, v84
  v_max3_f32 v85, v64, v65, v85
  v_max3_f32 v85, v66, v67, v85
  v_max3_f32 v85, v68, v69, v85
  v_max3_f32 v85, v70, v71, v85
  v_max3_f32 v86, v72, v73, v86
  v_max3_f32 v86, v74, v75, v86
  v_max3_f32 v86, v76, v77, v86
  v_max3_f32 v86, v78, v79, v86
  s_add_u32 s40, s40, 4096
  s_add_u32 s42, s42, 1
  s_cmp_lt_u32 s42, 8
  s_cbranch_scc1 L_fb_loop
  v_mov_b32 v32, v80
  v_mov_b32 v33, v81
  v_mov_b32 v34, v82
  v_mov_b32 v35, v83
  v_mov_b32 v36, v84
  v_mov_b32 v37, v85
  v_mov_b32 v38, v86
  v_mov_b32 v39, v87
  s_nop 1
  v_permlane16_swap_b32 v32, v80
  v_permlane16_swap_b32 v33, v81
  v_permlane16_swap_b32 v34, v82
  v_permlane16_swap_b32 v35, v83
  v_permlane16_swap_b32 v36, v84
  v_permlane16_swap_b32 v37, v85
  v_permlane16_swap_b32 v38, v86
  v_permlane16_swap_b32 v39, v87
  s_nop 1
  v_max_f32 v80, v80, v32
  v_max_f32 v81, v81, v33
  v_max_f32 v82, v82, v34
  v_max_f32 v83, v83, v35
  v_max_f32 v84, v84, v36
  v_max_f32 v85, v85, v37
  v_max_f32 v86, v86, v38
  v_max_f32 v87, v87, v39
  v_mov_b32 v32, v80
  v_mov_b32 v33, v81
  v_mov_b32 v34, v82
  v_mov_b32 v35, v83
  v_mov_b32 v36, v84
  v_mov_b32 v37, v85
  v_mov_b32 v38, v86
  v_mov_b32 v39, v87
  s_nop 1
  v_permlane32_swap_b32 v32, v80
  v_permlane32_swap_b32 v33, v81
  v_permlane32_swap_b32 v34, v82
  v_permlane32_swap_b32 v35, v83
  v_permlane32_swap_b32 v36, v84
  v_permlane32_swap_b32 v37, v85
  v_permlane32_swap_b32 v38, v86
  v_permlane32_swap_b32 v39, v87
  s_nop 1
  v_max_f32 v80, v80, v32
  v_max_f32 v81, v81, v33
  v_max_f32 v82, v82, v34
  v_max_f32 v83, v83, v35
  v_max_f32 v84, v84, v36
  v_max_f32 v85, v85, v37
  v_max_f32 v86, v86, v38
  v_max_f32_e64 v87, v87, v39
  ds_write_b128 v23, v[80:83] offset:24576
  ds_write_b128 v23, v[84:87] offset:25600
  s_waitcnt lgkmcnt(0)
  s_barrier
  ds_read_b128 v[40:43], v24 offset:24576
  ds_read_b128 v[44:47], v24 offset:25600
  ds_read_b128 v[48:51], v25 offset:25600
  ds_read_b128 v[52:55], v25 offset:24576
  ds_read_b128 v[56:59], v26 offset:25600
  ds_read_b128 v[60:63], v26 offset:24576
  s_waitcnt lgkmcnt(0)
  s_barrier
  v_max3_f32 v80, v80, v40, v48
  v_max_f32_e64 v80, v80, v56
  v_max3_f32 v81, v81, v41, v49
  v_max_f32_e64 v81, v81, v57
  v_max3_f32 v82, v82, v42, v50
  v_max_f32_e64 v82, v82, v58
  v_max3_f32 v83, v83, v43, v51
  v_max_f32_e64 v83, v83, v59
  v_max3_f32 v84, v84, v44, v52
  v_max_f32_e64 v84, v84, v60
  v_max3_f32 v85, v85, v45, v53
  v_max_f32_e64 v85, v85, v61
  v_max3_f32 v86, v86, v46, v54
  v_max_f32_e64 v86, v86, v62
  v_max3_f32 v87, v87, v47, v55
  v_max_f32 v87, v87, v63
  v_sub_f32 v88, 0, v80
  v_sub_f32 v89, 0, v80
  v_sub_f32 v90, 0, v80
  v_sub_f32 v91, 0, v80
  v_sub_f32 v92, 0, v81
  v_sub_f32 v93, 0, v81
  v_sub_f32 v94, 0, v81
  v_sub_f32 v95, 0, v81
  v_sub_f32 v96, 0, v82
  v_sub_f32 v97, 0, v82
  v_sub_f32 v98, 0, v82
  v_sub_f32 v99, 0, v82
  v_sub_f32 v100, 0, v84
  v_sub_f32 v101, 0, v84
  v_sub_f32 v102, 0, v84
  v_sub_f32 v103, 0, v84
  v_sub_f32 v104, 0, v85
  v_sub_f32 v105, 0, v85
  v_sub_f32 v106, 0, v85
  v_sub_f32 v107, 0, v85
  v_sub_f32 v108, 0, v86
  v_sub_f32 v109, 0, v86
  v_sub_f32 v110, 0, v86
  v_sub_f32 v111, 0, v86
  s_add_u32 m0, s35, 0
  s_nop 0
  s_nop 0
  buffer_load_dwordx4 v4, s[16:19], s64 offen offset:0 lds
  buffer_load_dwordx4 v5, s[16:19], s64 offen offset:1024 lds
  buffer_load_dwordx4 v6, s[16:19], s64 offen offset:2048 lds
  buffer_load_dwordx4 v7, s[16:19], s64 offen offset:3072 lds
  s_add_u32 m0, s35, 4096
  s_nop 0
  s_nop 0
  buffer_load_dwordx4 v4, s[16:19], s72 offen offset:0 lds
  buffer_load_dwordx4 v5, s[16:19], s72 offen offset:1024 lds
  buffer_load_dwordx4 v6, s[16:19], s72 offen offset:2048 lds
  buffer_load_dwordx4 v7, s[16:19], s72 offen offset:3072 lds
  s_waitcnt vmcnt(0)
  s_nop 0
  s_add_u32 m0, s35, 20480
  s_branch L_main
  s_nop 0
L_codeend:
.section .rodata,"a"
.p2align 6
.amdhsa_kernel standalone__gqa_softmax__near_ridge_kernel
  .amdhsa_next_free_vgpr 512
  .amdhsa_next_free_sgpr 102
  .amdhsa_accum_offset 256
  .amdhsa_group_segment_fixed_size 0
  .amdhsa_kernarg_size 48
  .amdhsa_user_sgpr_count 2
  .amdhsa_user_sgpr_kernarg_segment_ptr 1
  .amdhsa_system_sgpr_workgroup_id_x 1
.end_amdhsa_kernel
```
